```python
import torch

def _softmax(x, axis=-1):
    return torch.softmax(x, dim=axis)

def _gelu(x):
    return torch.nn.functional.gelu(x, approximate='tanh')

def _silu(x):
    return torch.nn.functional.silu(x)

def _sigmoid(x):
    return torch.sigmoid(x)

def _layernorm(x, axis=-1, eps=1e-05):
    m = x.mean(dim=axis, keepdim=True)
    v = x.var(dim=axis, keepdim=True, unbiased=False)
    return (x - m) / torch.sqrt(v + eps)

def _scatter_add(tgt, idx, src, axis=0):
    return tgt.clone().index_add_(axis, idx, src)

def _segment_sum(src, seg, n):
    out = torch.zeros((n,) + src.shape[1:], dtype=src.dtype)
    return out.index_add_(0, seg, src)

def _pad(x, pw):
    flat = tuple((v for pair in reversed(pw) for v in pair))
    return torch.nn.functional.pad(x, flat)
kernel_name = 'adaLN_cond__gqa_block_cached__glu_gated_geglu__decode'

def setup_inputs():

    _w = lambda a: (lambda t: t.to(torch.bfloat16) if t.is_floating_point() else t)(torch.as_tensor(a))

    def _A_setup():
        B, Sq, D = (1, 1, 1024)
        Hq, Hkv, Sk, Dh = (32, 4, 65536, 128)
        assert Hq % Hkv == 0, (Hq, Hkv)
        return {'x': _w((lambda *s: torch.randn(*s, dtype=torch.bfloat16) * 0.05)(B, Sq, D)), 'k_cache': _w((lambda *s: torch.randn(*s, dtype=torch.bfloat16) * 3.2)(B, Hkv, Sk, Dh)), 'v_cache': _w((lambda *s: torch.randn(*s, dtype=torch.bfloat16) * 3.2)(B, Hkv, Sk, Dh)), 'wq': _w((lambda *s: torch.randn(*s, dtype=torch.bfloat16) * 3.2)(D, Hq * Dh) * D ** (-0.5)), 'wo': _w((lambda *s: torch.randn(*s, dtype=torch.bfloat16) * 3.2)(Hq * Dh, D) * (Hq * Dh) ** (-0.5))}
    _A_in = _A_setup()

    def _B_setup():
        B, S, Dm, Df = (1, 1, 1024, 3584)
        return {'x': _w((lambda *s: torch.randn(*s, dtype=torch.bfloat16) * 0.05)(B, S, Dm)), 'w_gate': _w((lambda *s: torch.randn(*s, dtype=torch.bfloat16) * 3.2)(Dm, Df) * Dm ** (-0.5)), 'w_up': _w((lambda *s: torch.randn(*s, dtype=torch.bfloat16) * 3.2)(Dm, Df) * Dm ** (-0.5)), 'w_down': _w((lambda *s: torch.randn(*s, dtype=torch.bfloat16) * 3.2)(Df, Dm) * Df ** (-0.5))}
    _B_in = _B_setup()
    return {'A_x': _A_in['x'], 'A_k_cache': _A_in['k_cache'], 'A_v_cache': _A_in['v_cache'], 'A_wq': _A_in['wq'], 'A_wo': _A_in['wo'], 'B_x': _B_in['x'], 'B_w_gate': _B_in['w_gate'], 'B_w_up': _B_in['w_up'], 'B_w_down': _B_in['w_down'], 'c': _w((lambda *s: torch.randn(*s, dtype=torch.bfloat16) * 0.4)(1, 1024) * 8.0), 'w_mod': _w((lambda *s: torch.randn(*s, dtype=torch.bfloat16) * 0.4)(1024, 6 * 1024) * 1024 ** (-0.5) * 8.0)}

def reference(A_x, A_k_cache, A_v_cache, A_wq, A_wo, B_x, B_w_gate, B_w_up, B_w_down, c, w_mod):

    def _A_ref(x, k_cache, v_cache, wq, wo):
        B, Sq, D = x.shape
        Hq, Dh = (32, 128)
        Hkv = k_cache.shape[1]
        rep = Hq // Hkv
        q = (lambda x, *d: x.permute(*d))((x @ wq).reshape(B, Sq, Hq, Dh), 0, 2, 1, 3)
        k = (lambda x, n, axis: torch.repeat_interleave(x, n, dim=axis))(k_cache, rep, axis=1)
        v = (lambda x, n, axis: torch.repeat_interleave(x, n, dim=axis))(v_cache, rep, axis=1)
        scores = torch.einsum('bhqd,bhkd->bhqk', q, k) * Dh ** (-0.5)
        p = _softmax(scores, axis=-1)
        o = torch.einsum('bhqk,bhkd->bhqd', p, v)
        return (lambda x, *d: x.permute(*d))(o, 0, 2, 1, 3).reshape(B, Sq, Hq * Dh) @ wo

    def _B_ref(x, w_gate, w_up, w_down):
        g = torch.einsum('bsd,df->bsf', x, w_gate)
        u = torch.einsum('bsd,df->bsf', x, w_up)
        h = _gelu(g) * u
        return torch.einsum('bsf,fd->bsd', h, w_down)
    x = A_x
    mod = (_silu(c) @ w_mod).reshape(c.shape[0], 6, 1, -1)
    sa, ca, ga, sb, cb, gb = (mod[:, 0].clone(), mod[:, 1].clone(), mod[:, 2].clone(), mod[:, 3].clone(), mod[:, 4].clone(), mod[:, 5].clone())
    h = _layernorm(x, axis=-1) * (1 + ca) + sa
    x = x + ga * _A_ref(h, A_k_cache, A_v_cache, A_wq, A_wo)
    h = _layernorm(x, axis=-1) * (1 + cb) + sb
    x = x + gb * _B_ref(h, B_w_gate, B_w_up, B_w_down)
    return x
```

```asm
; @launch grid=(256,1,1) block=(768,1,1) lds=163840
.amdgcn_target "amdgcn-amd-amdhsa--gfx950"
.text
.globl adaLN_cond__gqa_block_cached__glu_gated_geglu__decode_kernel
.p2align 8
.type adaLN_cond__gqa_block_cached__glu_gated_geglu__decode_kernel,@function
adaLN_cond__gqa_block_cached__glu_gated_geglu__decode_kernel:
L_start:
    s_load_dwordx16 s[68:83], s[0:1], 0
    s_load_dwordx8 s[84:91], s[0:1], 64
    s_load_dwordx4 s[92:95], s[0:1], 96
    s_cmp_ge_u32 s2, 256
    s_cbranch_scc1 L_end
    v_lshrrev_b32 v2, 6, v0
    v_and_b32 v1, 63, v0
    v_readfirstlane_b32 s3, v2
    s_mov_b32 s4, 1048576
    s_cmp_ge_u32 s3, 8
    s_cbranch_scc1 L_cwave
    v_and_b32 v32, 15, v1
    v_lshrrev_b32 v33, 4, v1
    v_lshlrev_b32 v34, 1, v33
    v_xor_b32 v34, v34, v32
    v_lshlrev_b32 v34, 4, v34
    v_mul_u32_u24 v16, 12288, v33
    v_add_u32 v16, v16, v34
    s_and_b32 s63, s3, 1
    s_lshl_b32 s63, s63, 7
    v_xor_b32 v16, s63, v16
    v_lshl_add_u32 v17, v33, 13, v34
    s_lshr_b32 s5, s2, 4
    s_lshl_b32 s5, s5, 6
    s_lshl_b32 s6, s3, 3
    s_add_u32 s5, s5, s6
    s_mul_i32 s5, s5, 12288
    s_and_b32 s6, s2, 15
    s_lshl_b32 s6, s6, 8
    s_add_u32 s44, s5, s6
    s_lshl_b32 s51, s3, 11
    s_lshl_b32 s56, s3, 12
    s_and_b32 s52, s2, 7
    s_lshr_b32 s53, s2, 3
    s_lshl_b32 s5, s52, 7
    s_lshl_b32 s57, s3, 4
    s_add_u32 s54, s5, s57
    s_lshl_b32 s5, s54, 13
    s_lshl_b32 s55, s53, 8
    s_add_u32 s45, s5, s55
    s_waitcnt lgkmcnt(0)
    s_mov_b64 s[8:9], s[88:89]
    s_mov_b32 s10, 12582912
    s_mov_b32 s11, 0x20000
    s_mov_b64 s[12:13], s[74:75]
    s_mov_b32 s14, 8388608
    s_mov_b32 s15, 0x20000
    s_add_u32 m0, s51, 0
    s_add_u32 s50, s44, 0
    buffer_load_dwordx4 v16, s[8:11], s50 offen nt lds
    s_add_u32 m0, s51, 1024
    s_add_u32 s50, s44, 49152
    buffer_load_dwordx4 v16, s[8:11], s50 offen nt lds
    s_add_u32 m0, s56, 49152
    s_add_u32 s50, s45, 0
    buffer_load_dwordx4 v17, s[12:15], s50 offen nt lds
    v_mul_u32_u24 v4, 7168, v33
    v_add_u32 v4, v4, v34
    v_lshl_add_u32 v5, v33, 11, v34
    v_lshlrev_b32 v3, 4, v1
    v_and_b32 v35, 2, v32
    v_lshlrev_b32 v35, 15, v35
    v_lshrrev_b32 v36, 2, v32
    v_lshl_add_u32 v35, v36, 8, v35
    v_and_b32 v36, 1, v32
    v_lshl_add_u32 v35, v36, 6, v35
    v_lshl_add_u32 v2, v33, 4, v35
    v_mov_b32 v6, 147456
    v_mov_b32 v7, 1
    s_lshr_b32 s5, s2, 6
    s_lshl_b32 s5, s5, 3
    s_add_u32 s5, s5, s52
    s_lshl_b32 s5, s5, 7
    s_add_u32 s5, s5, s57
    s_lshl_b32 s5, s5, 11
    s_and_b32 s6, s53, 7
    s_lshl_b32 s6, s6, 8
    s_add_u32 s46, s5, s6
    s_and_b32 s5, s2, 3
    s_lshl_b32 s5, s5, 24
    s_bfe_u32 s6, s2, 0x10003
    s_lshl_b32 s6, s6, 18
    s_add_u32 s5, s5, s6
    s_bfe_u32 s6, s2, 0x10004
    s_lshl_b32 s6, s6, 19
    s_add_u32 s5, s5, s6
    s_bfe_u32 s6, s2, 0x10005
    s_lshl_b32 s6, s6, 20
    s_add_u32 s5, s5, s6
    s_bfe_u32 s6, s2, 0x10006
    s_lshl_b32 s6, s6, 21
    s_add_u32 s5, s5, s6
    s_bfe_u32 s6, s2, 0x10007
    s_lshl_b32 s6, s6, 22
    s_add_u32 s5, s5, s6
    s_bfe_u32 s6, s2, 0x10002
    s_lshl_b32 s6, s6, 23
    s_add_u32 s5, s5, s6
    s_lshl_b32 s6, s3, 10
    s_add_u32 s49, s5, s6
    s_mul_i32 s6, s2, 8
    s_lshr_b32 s6, s6, 3
    s_and_b32 s6, s6, 23
    s_lshl_b32 s6, s6, 13
    s_or_b32 s49, s49, s6
    s_mov_b64 s[16:17], s[76:77]
    s_mov_b32 s18, 8388608
    s_mov_b32 s19, 0x20000
    s_mov_b64 s[32:33], s[70:71]
    s_mov_b32 s34, 67108864
    s_mov_b32 s35, 0x20000
    s_mov_b64 s[36:37], s[72:73]
    s_mov_b32 s38, 67108864
    s_mov_b32 s39, 0x20000
    s_mov_b64 s[20:21], s[80:81]
    s_mov_b32 s22, 0
    s_mov_b32 s23, 0x20000
    s_mov_b64 s[24:25], s[82:83]
    s_mov_b32 s26, 0
    s_mov_b32 s27, 0x20000
    s_mov_b64 s[28:29], s[84:85]
    s_mov_b32 s30, 0
    s_mov_b32 s31, 0x20000
    s_mov_b32 s58, 0x05040100
    s_mov_b32 s59, 0x07060302
    s_barrier
    s_add_u32 m0, s56, 50176
    s_add_u32 s50, s45, 32768
    s_waitcnt vmcnt(2)
    buffer_load_dwordx4 v17, s[12:15], s50 offen nt lds
    v_xor_b32 v17, 0x80, v17
    s_add_u32 m0, s56, 51200
    s_add_u32 s50, s45, 65536
    s_waitcnt vmcnt(2)
    s_mov_b64 exec, 1
    ds_add_u32 v6, v7 offset:0
    s_mov_b64 exec, -1
    buffer_load_dwordx4 v17, s[12:15], s50 offen nt lds
    s_add_u32 m0, s56, 52224
    s_add_u32 s50, s45, 98304
    s_waitcnt vmcnt(2)
    buffer_load_dwordx4 v17, s[12:15], s50 offen nt lds
    v_xor_b32 v17, 0x80, v17
    s_add_u32 m0, s51, 16384
    s_add_u32 s50, s44, 4096
    s_waitcnt vmcnt(2)
    buffer_load_dwordx4 v16, s[8:11], s50 offen nt lds
    s_add_u32 m0, s51, 17408
    s_add_u32 s50, s44, 53248
    s_waitcnt vmcnt(2)
    buffer_load_dwordx4 v16, s[8:11], s50 offen nt lds
    s_add_u32 m0, s51, 32768
    s_add_u32 s50, s44, 8192
    s_waitcnt vmcnt(2)
    s_mov_b64 exec, 1
    ds_add_u32 v6, v7 offset:4
    s_mov_b64 exec, -1
    buffer_load_dwordx4 v16, s[8:11], s50 offen nt lds
    s_add_u32 m0, s51, 33792
    s_add_u32 s50, s44, 57344
    s_waitcnt vmcnt(2)
    buffer_load_dwordx4 v16, s[8:11], s50 offen nt lds
    s_xor_b32 s60, s49, 0
    s_waitcnt vmcnt(2)
    s_mov_b64 exec, 1
    ds_add_u32 v6, v7 offset:8
    s_mov_b64 exec, -1
    buffer_load_dwordx4 v[40:43], v2, s[32:35], s60 offen offset:0 nt
    s_waitcnt vmcnt(2)
    buffer_load_dwordx4 v[44:47], v2, s[32:35], s60 offen offset:128 nt
    s_xor_b32 s60, s49, 8192
    s_waitcnt vmcnt(2)
    s_mov_b64 exec, 1
    ds_add_u32 v6, v7 offset:12
    s_mov_b64 exec, -1
    buffer_load_dwordx4 v[48:51], v2, s[32:35], s60 offen offset:0 nt
    s_waitcnt vmcnt(2)
    buffer_load_dwordx4 v[52:55], v2, s[32:35], s60 offen offset:128 nt
    s_xor_b32 s60, s49, 16384
    s_waitcnt vmcnt(2)
    buffer_load_dwordx4 v[56:59], v2, s[32:35], s60 offen offset:0 nt
    s_waitcnt vmcnt(2)
    buffer_load_dwordx4 v[60:63], v2, s[32:35], s60 offen offset:128 nt
    s_xor_b32 s60, s49, 24576
    s_waitcnt vmcnt(2)
    buffer_load_dwordx4 v[64:67], v2, s[32:35], s60 offen offset:0 nt
    s_waitcnt vmcnt(2)
    buffer_load_dwordx4 v[68:71], v2, s[32:35], s60 offen offset:128 nt
    s_xor_b32 s60, s49, 32768
    s_waitcnt vmcnt(2)
    buffer_load_dwordx4 v[72:75], v2, s[32:35], s60 offen offset:0 nt
    s_mov_b64 exec, 1
    ds_add_u32 v6, v7 offset:52
    s_mov_b64 exec, -1
    s_waitcnt vmcnt(2)
    buffer_load_dwordx4 v[76:79], v2, s[32:35], s60 offen offset:128 nt
    s_xor_b32 s60, s49, 40960
    s_waitcnt vmcnt(2)
    buffer_load_dwordx4 v[80:83], v2, s[32:35], s60 offen offset:0 nt
    s_waitcnt vmcnt(2)
    buffer_load_dwordx4 v[84:87], v2, s[32:35], s60 offen offset:128 nt
    s_xor_b32 s60, s49, 49152
    s_waitcnt vmcnt(2)
    buffer_load_dwordx4 v[88:91], v2, s[32:35], s60 offen offset:0 nt
    s_waitcnt vmcnt(2)
    buffer_load_dwordx4 v[92:95], v2, s[32:35], s60 offen offset:128 nt
    s_xor_b32 s60, s49, 57344
    s_waitcnt vmcnt(2)
    buffer_load_dwordx4 v[96:99], v2, s[32:35], s60 offen offset:0 nt
    s_waitcnt vmcnt(2)
    buffer_load_dwordx4 v[100:103], v2, s[32:35], s60 offen offset:128 nt
    s_xor_b32 s60, s49, 131072
    s_waitcnt vmcnt(2)
    buffer_load_dwordx4 v[104:107], v2, s[32:35], s60 offen offset:0 nt
    s_waitcnt vmcnt(2)
    buffer_load_dwordx4 v[108:111], v2, s[32:35], s60 offen offset:128 nt
    s_xor_b32 s60, s49, 139264
    s_waitcnt vmcnt(2)
    buffer_load_dwordx4 v[112:115], v2, s[32:35], s60 offen offset:0 nt
    s_waitcnt vmcnt(2)
    buffer_load_dwordx4 v[116:119], v2, s[32:35], s60 offen offset:128 nt
    s_xor_b32 s60, s49, 147456
    s_waitcnt vmcnt(2)
    buffer_load_dwordx4 v[120:123], v2, s[32:35], s60 offen offset:0 nt
    s_waitcnt vmcnt(2)
    buffer_load_dwordx4 v[124:127], v2, s[32:35], s60 offen offset:128 nt
    s_xor_b32 s60, s49, 155648
    s_waitcnt vmcnt(2)
    buffer_load_dwordx4 v[128:131], v2, s[32:35], s60 offen offset:0 nt
    s_waitcnt vmcnt(2)
    buffer_load_dwordx4 v[132:135], v2, s[32:35], s60 offen offset:128 nt
    s_mov_b64 exec, 1
    ds_add_u32 v6, v7 offset:56
    s_mov_b64 exec, -1
    s_xor_b32 s60, s49, 163840
    s_waitcnt vmcnt(2)
    buffer_load_dwordx4 v[136:139], v2, s[32:35], s60 offen offset:0 nt
    s_waitcnt vmcnt(2)
    buffer_load_dwordx4 v[140:143], v2, s[32:35], s60 offen offset:128 nt
    s_xor_b32 s60, s49, 172032
    s_waitcnt vmcnt(2)
    buffer_load_dwordx4 v[144:147], v2, s[32:35], s60 offen offset:0 nt
    s_waitcnt vmcnt(2)
    buffer_load_dwordx4 v[148:151], v2, s[32:35], s60 offen offset:128 nt
    s_xor_b32 s60, s49, 180224
    s_waitcnt vmcnt(2)
    buffer_load_dwordx4 v[152:155], v2, s[32:35], s60 offen offset:0 nt
    s_waitcnt vmcnt(2)
    buffer_load_dwordx4 v[156:159], v2, s[32:35], s60 offen offset:128 nt
    s_xor_b32 s60, s49, 188416
    s_waitcnt vmcnt(2)
    buffer_load_dwordx4 v[160:163], v2, s[32:35], s60 offen offset:0 nt
    s_waitcnt vmcnt(2)
    buffer_load_dwordx4 v[164:167], v2, s[32:35], s60 offen offset:128 nt
    v_and_b32 v33, 7, v1
    v_lshlrev_b32 v33, 8, v33
    v_and_b32 v34, 8, v1
    v_lshl_add_u32 v33, v34, 3, v33
    v_lshrrev_b32 v34, 4, v1
    v_lshl_add_u32 v33, v34, 4, v33
    v_add_u32 v33, 147712, v33
    s_mov_b32 s61, 0x3db504f3
    s_mov_b32 s62, 0x3fb8aa3b
L_lw_1:
    ds_read_b32 v32, v6 offset:32
    s_waitcnt lgkmcnt(0)
    v_readfirstlane_b32 s5, v32
    s_nop 0
    s_cmp_ge_u32 s5, 4
    s_cbranch_scc1 L_lwd_2
    s_sleep 1
    s_sub_u32 s4, s4, 1
    s_cbranch_scc1 L_end
    s_branch L_lw_1
L_lwd_2:
    ds_read_b128 v[8:11], v33
    ds_read_b128 v[12:15], v33 offset:128
    s_waitcnt lgkmcnt(0)
    v_mfma_f32_16x16x32_bf16 v[32:35], v[40:43], v[8:11], 0
    v_mfma_f32_16x16x32_bf16 v[32:35], v[44:47], v[12:15], v[32:35]
    v_mfma_f32_16x16x32_bf16 v[36:39], v[48:51], v[8:11], 0
    v_mfma_f32_16x16x32_bf16 v[36:39], v[52:55], v[12:15], v[36:39]
    s_xor_b32 s60, s49, 0
    buffer_load_dwordx4 v[40:43], v3, s[36:39], s60 offen offset:0 nt
    s_nop 3
    v_add_f32_dpp v16, v33, v32 row_ror:8 row_mask:0xf bank_mask:0x3
    s_nop 1
    v_add_f32_dpp v16, v34, v35 row_ror:8 row_mask:0xf bank_mask:0xc
    v_mfma_f32_16x16x32_bf16 v[32:35], v[56:59], v[8:11], 0
    v_mfma_f32_16x16x32_bf16 v[32:35], v[60:63], v[12:15], v[32:35]
    v_cvt_pk_bf16_f32 v16, 0, v16
    v_mul_f32 v16, s61, v16
    v_cvt_pk_bf16_f32 v16, 0, v16
    v_add_f32_dpp v17, v37, v36 row_ror:8 row_mask:0xf bank_mask:0x3
    s_nop 1
    v_add_f32_dpp v17, v38, v39 row_ror:8 row_mask:0xf bank_mask:0xc
    v_mfma_f32_16x16x32_bf16 v[36:39], v[64:67], v[8:11], 0
    v_mfma_f32_16x16x32_bf16 v[36:39], v[68:71], v[12:15], v[36:39]
    s_xor_b32 s60, s49, 8192
    buffer_load_dwordx4 v[44:47], v3, s[36:39], s60 offen offset:0 nt
    v_cvt_pk_bf16_f32 v17, 0, v17
    v_mul_f32 v17, s61, v17
    v_cvt_pk_bf16_f32 v17, 0, v17
    v_add_f32_dpp v18, v33, v32 row_ror:8 row_mask:0xf bank_mask:0x3
    s_nop 1
    v_add_f32_dpp v18, v34, v35 row_ror:8 row_mask:0xf bank_mask:0xc
    v_mfma_f32_16x16x32_bf16 v[32:35], v[72:75], v[8:11], 0
    v_mfma_f32_16x16x32_bf16 v[32:35], v[76:79], v[12:15], v[32:35]
    v_cvt_pk_bf16_f32 v18, 0, v18
    v_mul_f32 v18, s61, v18
    v_cvt_pk_bf16_f32 v18, 0, v18
    v_add_f32_dpp v19, v37, v36 row_ror:8 row_mask:0xf bank_mask:0x3
    s_nop 1
    v_add_f32_dpp v19, v38, v39 row_ror:8 row_mask:0xf bank_mask:0xc
    v_mfma_f32_16x16x32_bf16 v[36:39], v[80:83], v[8:11], 0
    v_mfma_f32_16x16x32_bf16 v[36:39], v[84:87], v[12:15], v[36:39]
    s_xor_b32 s60, s49, 16384
    buffer_load_dwordx4 v[48:51], v3, s[36:39], s60 offen offset:0 nt
    v_cvt_pk_bf16_f32 v19, 0, v19
    v_mul_f32 v19, s61, v19
    v_cvt_pk_bf16_f32 v19, 0, v19
    v_add_f32_dpp v20, v33, v32 row_ror:8 row_mask:0xf bank_mask:0x3
    s_nop 1
    v_add_f32_dpp v20, v34, v35 row_ror:8 row_mask:0xf bank_mask:0xc
    v_mfma_f32_16x16x32_bf16 v[32:35], v[88:91], v[8:11], 0
    v_mfma_f32_16x16x32_bf16 v[32:35], v[92:95], v[12:15], v[32:35]
    v_cvt_pk_bf16_f32 v20, 0, v20
    v_mul_f32 v20, s61, v20
    v_cvt_pk_bf16_f32 v20, 0, v20
    v_add_f32_dpp v21, v37, v36 row_ror:8 row_mask:0xf bank_mask:0x3
    s_nop 1
    v_add_f32_dpp v21, v38, v39 row_ror:8 row_mask:0xf bank_mask:0xc
    v_mfma_f32_16x16x32_bf16 v[36:39], v[96:99], v[8:11], 0
    v_mfma_f32_16x16x32_bf16 v[36:39], v[100:103], v[12:15], v[36:39]
    v_cvt_pk_bf16_f32 v21, 0, v21
    v_mul_f32 v21, s61, v21
    v_cvt_pk_bf16_f32 v21, 0, v21
    v_add_f32_dpp v22, v33, v32 row_ror:8 row_mask:0xf bank_mask:0x3
    s_nop 1
    v_add_f32_dpp v22, v34, v35 row_ror:8 row_mask:0xf bank_mask:0xc
    v_mfma_f32_16x16x32_bf16 v[32:35], v[104:107], v[8:11], 0
    v_mfma_f32_16x16x32_bf16 v[32:35], v[108:111], v[12:15], v[32:35]
    v_cvt_pk_bf16_f32 v22, 0, v22
    v_mul_f32 v22, s61, v22
    v_cvt_pk_bf16_f32 v22, 0, v22
    v_add_f32_dpp v23, v37, v36 row_ror:8 row_mask:0xf bank_mask:0x3
    s_nop 1
    v_add_f32_dpp v23, v38, v39 row_ror:8 row_mask:0xf bank_mask:0xc
    v_mfma_f32_16x16x32_bf16 v[36:39], v[112:115], v[8:11], 0
    v_mfma_f32_16x16x32_bf16 v[36:39], v[116:119], v[12:15], v[36:39]
    v_cvt_pk_bf16_f32 v23, 0, v23
    v_mul_f32 v23, s61, v23
    v_cvt_pk_bf16_f32 v23, 0, v23
    v_add_f32_dpp v24, v33, v32 row_ror:8 row_mask:0xf bank_mask:0x3
    s_nop 1
    v_add_f32_dpp v24, v34, v35 row_ror:8 row_mask:0xf bank_mask:0xc
    v_mfma_f32_16x16x32_bf16 v[32:35], v[120:123], v[8:11], 0
    v_mfma_f32_16x16x32_bf16 v[32:35], v[124:127], v[12:15], v[32:35]
    v_cvt_pk_bf16_f32 v24, 0, v24
    v_mul_f32 v24, s61, v24
    v_cvt_pk_bf16_f32 v24, 0, v24
    v_add_f32_dpp v25, v37, v36 row_ror:8 row_mask:0xf bank_mask:0x3
    s_nop 1
    v_add_f32_dpp v25, v38, v39 row_ror:8 row_mask:0xf bank_mask:0xc
    v_mfma_f32_16x16x32_bf16 v[36:39], v[128:131], v[8:11], 0
    v_mfma_f32_16x16x32_bf16 v[36:39], v[132:135], v[12:15], v[36:39]
    v_cvt_pk_bf16_f32 v25, 0, v25
    v_mul_f32 v25, s61, v25
    v_cvt_pk_bf16_f32 v25, 0, v25
    v_add_f32_dpp v26, v33, v32 row_ror:8 row_mask:0xf bank_mask:0x3
    s_nop 1
    v_add_f32_dpp v26, v34, v35 row_ror:8 row_mask:0xf bank_mask:0xc
    v_mfma_f32_16x16x32_bf16 v[32:35], v[136:139], v[8:11], 0
    v_mfma_f32_16x16x32_bf16 v[32:35], v[140:143], v[12:15], v[32:35]
    v_cvt_pk_bf16_f32 v26, 0, v26
    v_mul_f32 v26, s61, v26
    v_cvt_pk_bf16_f32 v26, 0, v26
    v_add_f32_dpp v27, v37, v36 row_ror:8 row_mask:0xf bank_mask:0x3
    s_nop 1
    v_add_f32_dpp v27, v38, v39 row_ror:8 row_mask:0xf bank_mask:0xc
    v_mfma_f32_16x16x32_bf16 v[36:39], v[144:147], v[8:11], 0
    v_mfma_f32_16x16x32_bf16 v[36:39], v[148:151], v[12:15], v[36:39]
    v_cvt_pk_bf16_f32 v27, 0, v27
    v_mul_f32 v27, s61, v27
    v_cvt_pk_bf16_f32 v27, 0, v27
    v_add_f32_dpp v28, v33, v32 row_ror:8 row_mask:0xf bank_mask:0x3
    s_nop 1
    v_add_f32_dpp v28, v34, v35 row_ror:8 row_mask:0xf bank_mask:0xc
    s_waitcnt vmcnt(5)
    v_mfma_f32_16x16x32_bf16 v[32:35], v[152:155], v[8:11], 0
    v_mfma_f32_16x16x32_bf16 v[32:35], v[156:159], v[12:15], v[32:35]
    v_cvt_pk_bf16_f32 v28, 0, v28
    v_mul_f32 v28, s61, v28
    v_cvt_pk_bf16_f32 v28, 0, v28
    v_add_f32_dpp v29, v37, v36 row_ror:8 row_mask:0xf bank_mask:0x3
    s_nop 1
    v_add_f32_dpp v29, v38, v39 row_ror:8 row_mask:0xf bank_mask:0xc
    s_waitcnt vmcnt(3)
    v_mfma_f32_16x16x32_bf16 v[36:39], v[160:163], v[8:11], 0
    v_mfma_f32_16x16x32_bf16 v[36:39], v[164:167], v[12:15], v[36:39]
    v_cvt_pk_bf16_f32 v29, 0, v29
    v_mul_f32 v29, s61, v29
    v_cvt_pk_bf16_f32 v29, 0, v29
    v_add_f32_dpp v30, v33, v32 row_ror:8 row_mask:0xf bank_mask:0x3
    s_nop 1
    v_add_f32_dpp v30, v34, v35 row_ror:8 row_mask:0xf bank_mask:0xc
    s_nop 0
    v_add_f32_dpp v31, v37, v36 row_ror:8 row_mask:0xf bank_mask:0x3
    s_nop 1
    v_add_f32_dpp v31, v38, v39 row_ror:8 row_mask:0xf bank_mask:0xc
    v_cvt_pk_bf16_f32 v30, 0, v30
    v_mul_f32 v30, s61, v30
    v_cvt_pk_bf16_f32 v30, 0, v30
    v_cvt_pk_bf16_f32 v31, 0, v31
    v_mul_f32 v31, s61, v31
    v_cvt_pk_bf16_f32 v31, 0, v31
    v_max3_f32 v32, v16, v17, v18
    v_max3_f32 v32, v32, v19, v20
    v_max3_f32 v32, v32, v21, v22
    v_max3_f32 v32, v32, v23, v24
    v_max3_f32 v32, v32, v25, v26
    v_max3_f32 v32, v32, v27, v28
    v_max3_f32 v32, v32, v29, v30
    v_max_f32 v32, v32, v31
    s_nop 1
    v_max_f32_dpp v32, v32, v32 row_ror:8 row_mask:0xf bank_mask:0xf
    v_mov_b32 v34, v32
    s_nop 1
    v_permlane16_swap_b32 v32, v34
    v_max_f32 v32, v32, v34
    v_mov_b32 v34, v32
    s_nop 1
    v_permlane32_swap_b32 v32, v34
    v_max_f32 v32, v32, v34
    v_sub_f32 v16, v16, v32
    v_mul_f32 v16, s62, v16
    v_exp_f32 v16, v16
    v_sub_f32 v17, v17, v32
    v_mul_f32 v17, s62, v17
    v_exp_f32 v17, v17
    v_sub_f32 v18, v18, v32
    v_mul_f32 v18, s62, v18
    v_exp_f32 v18, v18
    v_add_f32 v33, v16, v17
    v_sub_f32 v19, v19, v32
    v_mul_f32 v19, s62, v19
    v_exp_f32 v19, v19
    v_add_f32 v33, v33, v18
    v_sub_f32 v20, v20, v32
    v_mul_f32 v20, s62, v20
    v_exp_f32 v20, v20
    v_add_f32 v33, v33, v19
    v_sub_f32 v21, v21, v32
    v_mul_f32 v21, s62, v21
    v_exp_f32 v21, v21
    v_add_f32 v33, v33, v20
    v_sub_f32 v22, v22, v32
    v_mul_f32 v22, s62, v22
    v_exp_f32 v22, v22
    v_add_f32 v33, v33, v21
    v_sub_f32 v23, v23, v32
    v_mul_f32 v23, s62, v23
    v_exp_f32 v23, v23
    v_add_f32 v33, v33, v22
    v_sub_f32 v24, v24, v32
    v_mul_f32 v24, s62, v24
    v_exp_f32 v24, v24
    v_add_f32 v33, v33, v23
    v_sub_f32 v25, v25, v32
    v_mul_f32 v25, s62, v25
    v_exp_f32 v25, v25
    v_add_f32 v33, v33, v24
    v_sub_f32 v26, v26, v32
    v_mul_f32 v26, s62, v26
    v_exp_f32 v26, v26
    v_add_f32 v33, v33, v25
    v_sub_f32 v27, v27, v32
    v_mul_f32 v27, s62, v27
    v_exp_f32 v27, v27
    v_add_f32 v33, v33, v26
    v_sub_f32 v28, v28, v32
    v_mul_f32 v28, s62, v28
    v_exp_f32 v28, v28
    v_add_f32 v33, v33, v27
    v_sub_f32 v29, v29, v32
    v_mul_f32 v29, s62, v29
    v_exp_f32 v29, v29
    v_add_f32 v33, v33, v28
    v_sub_f32 v30, v30, v32
    v_mul_f32 v30, s62, v30
    v_exp_f32 v30, v30
    v_add_f32 v33, v33, v29
    v_sub_f32 v31, v31, v32
    v_mul_f32 v31, s62, v31
    v_exp_f32 v31, v31
    v_add_f32 v33, v33, v30
    v_mov_b32 v2, v32
    v_add_f32 v33, v33, v31
    s_nop 1
    v_add_f32_dpp v33, v33, v33 row_ror:8 row_mask:0xf bank_mask:0xf
    v_mov_b32 v34, v33
    s_nop 1
    v_permlane16_swap_b32 v33, v34
    v_add_f32 v33, v33, v34
    v_mov_b32 v34, v33
    s_nop 1
    v_permlane32_swap_b32 v33, v34
    v_add_f32 v33, v33, v34
    s_lshl_b32 s5, s3, 6
    s_add_u32 s5, s5, 151040
    v_lshlrev_b32 v34, 3, v1
    v_add_u32 v34, s5, v34
    s_mov_b64 exec, 0xff
    ds_write_b64 v34, v[32:33]
    s_waitcnt lgkmcnt(0)
    s_mov_b64 exec, 1
    ds_add_u32 v6, v7 offset:40
    s_mov_b64 exec, -1
    s_mov_b64 exec, 1
    ds_add_rtn_u32 v32, v6, v7 offset:80
    s_mov_b64 exec, -1
    s_waitcnt lgkmcnt(0)
    v_readfirstlane_b32 s5, v32
    s_nop 0
    s_cmp_gt_i32 s5, -12
    s_cselect_b64 vcc, -1, 0
    s_cbranch_scc1 L_go_3
    s_waitcnt vmcnt(1)
L_go_3:
    s_xor_b32 s60, s49, 24576
    buffer_load_dwordx4 v[52:55], v3, s[36:39], s60 offen offset:0 nt
    s_mov_b64 exec, 1
    ds_add_rtn_u32 v32, v6, v7 offset:80
    s_mov_b64 exec, -1
    s_waitcnt lgkmcnt(0)
    v_readfirstlane_b32 s5, v32
    s_nop 0
    s_cmp_gt_i32 s5, -4
    s_cselect_b64 vcc, -1, 0
    s_cbranch_scc1 L_go_4
    s_waitcnt vmcnt(1)
L_go_4:
    s_xor_b32 s60, s49, 32768
    buffer_load_dwordx4 v[56:59], v3, s[36:39], s60 offen offset:0 nt
    s_mov_b64 exec, 1
    ds_add_rtn_u32 v32, v6, v7 offset:80
    s_mov_b64 exec, -1
    s_waitcnt vmcnt(4)
    s_waitcnt lgkmcnt(0)
    v_readfirstlane_b32 s5, v32
    s_nop 0
    s_cmp_gt_i32 s5, 4
    s_cselect_b64 vcc, -1, 0
    s_cbranch_scc1 L_go_5
    s_waitcnt vmcnt(1)
L_go_5:
    s_xor_b32 s60, s49, 40960
    buffer_load_dwordx4 v[60:63], v3, s[36:39], s60 offen offset:0 nt
    s_mov_b64 exec, 1
    ds_add_rtn_u32 v32, v6, v7 offset:80
    s_mov_b64 exec, -1
    s_waitcnt vmcnt(4)
    s_waitcnt lgkmcnt(0)
    v_readfirstlane_b32 s5, v32
    s_nop 0
    s_cmp_gt_i32 s5, 12
    s_cselect_b64 vcc, -1, 0
    s_cbranch_scc1 L_go_6
    s_waitcnt vmcnt(1)
L_go_6:
    s_xor_b32 s60, s49, 49152
    buffer_load_dwordx4 v[64:67], v3, s[36:39], s60 offen offset:0 nt
    s_mov_b64 exec, 1
    ds_add_rtn_u32 v32, v6, v7 offset:80
    s_mov_b64 exec, -1
    s_waitcnt vmcnt(4)
    s_waitcnt lgkmcnt(0)
    v_readfirstlane_b32 s5, v32
    s_nop 0
    s_cmp_gt_i32 s5, 20
    s_cselect_b64 vcc, -1, 0
    s_cbranch_scc1 L_go_7
    s_waitcnt vmcnt(1)
L_go_7:
    s_xor_b32 s60, s49, 57344
    buffer_load_dwordx4 v[68:71], v3, s[36:39], s60 offen offset:0 nt
    s_mov_b64 exec, 1
    ds_add_rtn_u32 v32, v6, v7 offset:80
    s_mov_b64 exec, -1
    s_waitcnt vmcnt(4)
    s_waitcnt lgkmcnt(0)
    v_readfirstlane_b32 s5, v32
    s_nop 0
    s_cmp_gt_i32 s5, 28
    s_cselect_b64 vcc, -1, 0
    s_cbranch_scc1 L_go_8
    s_waitcnt vmcnt(1)
L_go_8:
    s_xor_b32 s60, s49, 65536
    buffer_load_dwordx4 v[72:75], v3, s[36:39], s60 offen offset:0 nt
    s_mov_b64 exec, 1
    ds_add_rtn_u32 v32, v6, v7 offset:80
    s_mov_b64 exec, -1
    s_waitcnt vmcnt(4)
    s_waitcnt lgkmcnt(0)
    v_readfirstlane_b32 s5, v32
    s_nop 0
    s_cmp_gt_i32 s5, 36
    s_cselect_b64 vcc, -1, 0
    s_cbranch_scc1 L_go_9
    s_waitcnt vmcnt(1)
L_go_9:
    s_xor_b32 s60, s49, 73728
    buffer_load_dwordx4 v[76:79], v3, s[36:39], s60 offen offset:0 nt
    s_mov_b64 exec, 1
    ds_add_rtn_u32 v32, v6, v7 offset:80
    s_mov_b64 exec, -1
    s_waitcnt vmcnt(4)
    s_waitcnt lgkmcnt(0)
    v_readfirstlane_b32 s5, v32
    s_nop 0
    s_cmp_gt_i32 s5, 44
    s_cselect_b64 vcc, -1, 0
    s_cbranch_scc1 L_go_10
    s_waitcnt vmcnt(1)
L_go_10:
    s_xor_b32 s60, s49, 81920
    buffer_load_dwordx4 v[80:83], v3, s[36:39], s60 offen offset:0 nt
    s_mov_b64 exec, 1
    ds_add_rtn_u32 v32, v6, v7 offset:80
    s_mov_b64 exec, -1
    s_waitcnt vmcnt(4)
    s_waitcnt lgkmcnt(0)
    v_readfirstlane_b32 s5, v32
    s_nop 0
    s_cmp_gt_i32 s5, 52
    s_cselect_b64 vcc, -1, 0
    s_cbranch_scc1 L_go_11
    s_waitcnt vmcnt(1)
L_go_11:
    s_xor_b32 s60, s49, 90112
    buffer_load_dwordx4 v[84:87], v3, s[36:39], s60 offen offset:0 nt
    s_mov_b64 exec, 1
    ds_add_rtn_u32 v32, v6, v7 offset:80
    s_mov_b64 exec, -1
    s_waitcnt vmcnt(4)
    s_waitcnt lgkmcnt(0)
    v_readfirstlane_b32 s5, v32
    s_nop 0
    s_cmp_gt_i32 s5, 60
    s_cselect_b64 vcc, -1, 0
    s_cbranch_scc1 L_go_12
    s_waitcnt vmcnt(1)
L_go_12:
    s_xor_b32 s60, s49, 98304
    buffer_load_dwordx4 v[88:91], v3, s[36:39], s60 offen offset:0 nt
    s_mov_b64 exec, 1
    ds_add_rtn_u32 v32, v6, v7 offset:80
    s_mov_b64 exec, -1
    s_waitcnt vmcnt(4)
    s_waitcnt lgkmcnt(0)
    v_readfirstlane_b32 s5, v32
    s_nop 0
    s_cmp_gt_i32 s5, 68
    s_cselect_b64 vcc, -1, 0
    s_cbranch_scc1 L_go_13
    s_waitcnt vmcnt(1)
L_go_13:
    s_xor_b32 s60, s49, 106496
    buffer_load_dwordx4 v[92:95], v3, s[36:39], s60 offen offset:0 nt
    s_mov_b64 exec, 1
    ds_add_rtn_u32 v32, v6, v7 offset:80
    s_mov_b64 exec, -1
    s_waitcnt vmcnt(4)
    s_waitcnt lgkmcnt(0)
    v_readfirstlane_b32 s5, v32
    s_nop 0
    s_cmp_gt_i32 s5, 76
    s_cselect_b64 vcc, -1, 0
    s_cbranch_scc1 L_go_14
    s_waitcnt vmcnt(1)
L_go_14:
    s_xor_b32 s60, s49, 114688
    buffer_load_dwordx4 v[96:99], v3, s[36:39], s60 offen offset:0 nt
    s_mov_b64 exec, 1
    ds_add_rtn_u32 v32, v6, v7 offset:80
    s_mov_b64 exec, -1
    s_waitcnt vmcnt(4)
    s_waitcnt lgkmcnt(0)
    v_readfirstlane_b32 s5, v32
    s_nop 0
    s_cmp_gt_i32 s5, 84
    s_cselect_b64 vcc, -1, 0
    s_cbranch_scc1 L_go_15
    s_waitcnt vmcnt(1)
L_go_15:
    s_xor_b32 s60, s49, 122880
    buffer_load_dwordx4 v[100:103], v3, s[36:39], s60 offen offset:0 nt
    s_mov_b64 exec, 1
    ds_add_rtn_u32 v32, v6, v7 offset:80
    s_mov_b64 exec, -1
    s_waitcnt vmcnt(4)
    s_waitcnt lgkmcnt(0)
    v_readfirstlane_b32 s5, v32
    s_nop 0
    s_cmp_gt_i32 s5, 92
    s_cselect_b64 vcc, -1, 0
    s_cbranch_scc1 L_go_16
    s_waitcnt vmcnt(1)
L_go_16:
    s_xor_b32 s60, s49, 131072
    buffer_load_dwordx4 v[104:107], v3, s[36:39], s60 offen offset:0 nt
    s_mov_b64 exec, 1
    ds_add_rtn_u32 v32, v6, v7 offset:80
    s_mov_b64 exec, -1
    s_waitcnt vmcnt(4)
    s_waitcnt lgkmcnt(0)
    v_readfirstlane_b32 s5, v32
    s_nop 0
    s_cmp_gt_i32 s5, 100
    s_cselect_b64 vcc, -1, 0
    s_cbranch_scc1 L_go_17
    s_waitcnt vmcnt(1)
L_go_17:
    s_xor_b32 s60, s49, 139264
    buffer_load_dwordx4 v[108:111], v3, s[36:39], s60 offen offset:0 nt
    s_mov_b64 exec, 1
    ds_add_rtn_u32 v32, v6, v7 offset:80
    s_mov_b64 exec, -1
    s_waitcnt vmcnt(4)
    s_waitcnt lgkmcnt(0)
    v_readfirstlane_b32 s5, v32
    s_nop 0
    s_cmp_gt_i32 s5, 108
    s_cselect_b64 vcc, -1, 0
    s_cbranch_scc1 L_go_18
    s_waitcnt vmcnt(1)
L_go_18:
    s_xor_b32 s60, s49, 147456
    buffer_load_dwordx4 v[112:115], v3, s[36:39], s60 offen offset:0 nt
    s_mov_b64 exec, 1
    ds_add_rtn_u32 v32, v6, v7 offset:80
    s_mov_b64 exec, -1
    s_waitcnt vmcnt(4)
    s_waitcnt lgkmcnt(0)
    v_readfirstlane_b32 s5, v32
    s_nop 0
    s_cmp_gt_i32 s5, 116
    s_cselect_b64 vcc, -1, 0
    s_cbranch_scc1 L_go_19
    s_waitcnt vmcnt(1)
L_go_19:
    s_xor_b32 s60, s49, 155648
    buffer_load_dwordx4 v[116:119], v3, s[36:39], s60 offen offset:0 nt
    s_mov_b64 exec, 1
    ds_add_rtn_u32 v32, v6, v7 offset:80
    s_mov_b64 exec, -1
    s_waitcnt vmcnt(4)
    s_waitcnt lgkmcnt(0)
    v_readfirstlane_b32 s5, v32
    s_nop 0
    s_cmp_gt_i32 s5, 124
    s_cselect_b64 vcc, -1, 0
    s_cbranch_scc1 L_go_20
    s_waitcnt vmcnt(1)
L_go_20:
    s_xor_b32 s60, s49, 163840
    buffer_load_dwordx4 v[120:123], v3, s[36:39], s60 offen offset:0 nt
    s_mov_b64 exec, 1
    ds_add_rtn_u32 v32, v6, v7 offset:80
    s_mov_b64 exec, -1
    s_waitcnt vmcnt(4)
    s_waitcnt lgkmcnt(0)
    v_readfirstlane_b32 s5, v32
    s_nop 0
    s_cmp_gt_i32 s5, 132
    s_cselect_b64 vcc, -1, 0
    s_cbranch_scc1 L_go_21
    s_waitcnt vmcnt(1)
L_go_21:
    s_xor_b32 s60, s49, 172032
    buffer_load_dwordx4 v[124:127], v3, s[36:39], s60 offen offset:0 nt
    s_mov_b64 exec, 1
    ds_add_rtn_u32 v32, v6, v7 offset:80
    s_mov_b64 exec, -1
    s_waitcnt vmcnt(4)
    s_waitcnt lgkmcnt(0)
    v_readfirstlane_b32 s5, v32
    s_nop 0
    s_cmp_gt_i32 s5, 140
    s_cselect_b64 vcc, -1, 0
    s_cbranch_scc1 L_go_22
    s_waitcnt vmcnt(1)
L_go_22:
    s_xor_b32 s60, s49, 180224
    buffer_load_dwordx4 v[128:131], v3, s[36:39], s60 offen offset:0 nt
    s_mov_b64 exec, 1
    ds_add_u32 v6, v7 offset:60
    s_mov_b64 exec, -1
    s_mov_b64 exec, 1
    ds_add_rtn_u32 v32, v6, v7 offset:80
    s_mov_b64 exec, -1
    s_waitcnt vmcnt(4)
    s_waitcnt lgkmcnt(0)
    v_readfirstlane_b32 s5, v32
    s_nop 0
    s_cmp_gt_i32 s5, 148
    s_cselect_b64 vcc, -1, 0
    s_cbranch_scc1 L_go_23
    s_waitcnt vmcnt(1)
L_go_23:
    s_xor_b32 s60, s49, 188416
    buffer_load_dwordx4 v[132:135], v3, s[36:39], s60 offen offset:0 nt
    s_mov_b64 exec, 1
    ds_add_rtn_u32 v32, v6, v7 offset:80
    s_mov_b64 exec, -1
    s_waitcnt vmcnt(4)
    s_waitcnt lgkmcnt(0)
    v_readfirstlane_b32 s5, v32
    s_nop 0
    s_cmp_gt_i32 s5, 156
    s_cselect_b64 vcc, -1, 0
    s_cbranch_scc1 L_go_24
    s_waitcnt vmcnt(1)
L_go_24:
    s_xor_b32 s60, s49, 196608
    buffer_load_dwordx4 v[136:139], v3, s[36:39], s60 offen offset:0 nt
    s_mov_b64 exec, 1
    ds_add_rtn_u32 v32, v6, v7 offset:80
    s_mov_b64 exec, -1
    s_waitcnt vmcnt(4)
    s_waitcnt lgkmcnt(0)
    v_readfirstlane_b32 s5, v32
    s_nop 0
    s_cmp_gt_i32 s5, 164
    s_cselect_b64 vcc, -1, 0
    s_cbranch_scc1 L_go_25
    s_waitcnt vmcnt(1)
L_go_25:
    s_xor_b32 s60, s49, 204800
    buffer_load_dwordx4 v[140:143], v3, s[36:39], s60 offen offset:0 nt
    s_mov_b64 exec, 1
    ds_add_rtn_u32 v32, v6, v7 offset:80
    s_mov_b64 exec, -1
    s_waitcnt vmcnt(4)
    s_waitcnt lgkmcnt(0)
    v_readfirstlane_b32 s5, v32
    s_nop 0
    s_cmp_gt_i32 s5, 172
    s_cselect_b64 vcc, -1, 0
    s_cbranch_scc1 L_go_26
    s_waitcnt vmcnt(1)
L_go_26:
    s_xor_b32 s60, s49, 212992
    buffer_load_dwordx4 v[144:147], v3, s[36:39], s60 offen offset:0 nt
    s_mov_b64 exec, 1
    ds_add_rtn_u32 v32, v6, v7 offset:80
    s_mov_b64 exec, -1
    s_waitcnt vmcnt(4)
    s_waitcnt lgkmcnt(0)
    v_readfirstlane_b32 s5, v32
    s_nop 0
    s_cmp_gt_i32 s5, 180
    s_cselect_b64 vcc, -1, 0
    s_cbranch_scc1 L_go_27
    s_waitcnt vmcnt(1)
L_go_27:
    s_xor_b32 s60, s49, 221184
    buffer_load_dwordx4 v[148:151], v3, s[36:39], s60 offen offset:0 nt
    s_mov_b64 exec, 1
    ds_add_rtn_u32 v32, v6, v7 offset:80
    s_mov_b64 exec, -1
    s_waitcnt vmcnt(4)
    s_waitcnt lgkmcnt(0)
    v_readfirstlane_b32 s5, v32
    s_nop 0
    s_cmp_gt_i32 s5, 188
    s_cselect_b64 vcc, -1, 0
    s_cbranch_scc1 L_go_28
    s_waitcnt vmcnt(1)
L_go_28:
    s_xor_b32 s60, s49, 229376
    buffer_load_dwordx4 v[152:155], v3, s[36:39], s60 offen offset:0 nt
    s_mov_b64 exec, 1
    ds_add_rtn_u32 v32, v6, v7 offset:80
    s_mov_b64 exec, -1
    s_waitcnt vmcnt(4)
    s_waitcnt lgkmcnt(0)
    v_readfirstlane_b32 s5, v32
    s_nop 0
    s_cmp_gt_i32 s5, 196
    s_cselect_b64 vcc, -1, 0
    s_cbranch_scc1 L_go_29
    s_waitcnt vmcnt(1)
L_go_29:
    s_xor_b32 s60, s49, 237568
    buffer_load_dwordx4 v[156:159], v3, s[36:39], s60 offen offset:0 nt
    s_mov_b64 exec, 1
    ds_add_rtn_u32 v32, v6, v7 offset:80
    s_mov_b64 exec, -1
    s_waitcnt vmcnt(4)
    s_waitcnt lgkmcnt(0)
    v_readfirstlane_b32 s5, v32
    s_nop 0
    s_cmp_gt_i32 s5, 204
    s_cselect_b64 vcc, -1, 0
    s_cbranch_scc1 L_go_30
    s_waitcnt vmcnt(1)
L_go_30:
    s_xor_b32 s60, s49, 245760
    buffer_load_dwordx4 v[160:163], v3, s[36:39], s60 offen offset:0 nt
    s_mov_b64 exec, 1
    ds_add_rtn_u32 v32, v6, v7 offset:80
    s_mov_b64 exec, -1
    s_waitcnt vmcnt(4)
    s_waitcnt lgkmcnt(0)
    v_readfirstlane_b32 s5, v32
    s_nop 0
    s_cmp_gt_i32 s5, 212
    s_cselect_b64 vcc, -1, 0
    s_cbranch_scc1 L_go_31
    s_waitcnt vmcnt(1)
L_go_31:
    s_xor_b32 s60, s49, 253952
    buffer_load_dwordx4 v[164:167], v3, s[36:39], s60 offen offset:0 nt
    s_mov_b64 exec, 1
    ds_add_u32 v6, v7 offset:100
    s_mov_b64 exec, -1
    v_and_b32 v34, 7, v1
    v_lshlrev_b32 v34, 3, v34
    v_add_u32 v34, 151552, v34
L_lw_32:
    ds_read_b32 v32, v6 offset:72
    s_waitcnt lgkmcnt(0)
    v_readfirstlane_b32 s5, v32
    s_nop 0
    s_cmp_ge_u32 s5, 1
    s_cbranch_scc1 L_lwd_33
    s_sub_u32 s4, s4, 1
    s_cbranch_scc1 L_end
    s_branch L_lw_32
L_lwd_33:
    s_sub_u32 s7, s5, 1
    s_mov_b32 s5, 7340032
    s_cmp_lt_u32 s7, 224
    s_cselect_b32 s5, s5, 0
    s_mov_b32 s22, s5
    s_mov_b32 s26, s5
    s_mov_b32 s30, s5
    s_and_b32 s52, s7, 7
    s_lshr_b32 s53, s7, 3
    s_lshl_b32 s5, s52, 7
    s_add_u32 s5, s5, s57
    s_mul_i32 s5, s5, 7168
    s_lshl_b32 s6, s53, 8
    s_add_u32 s47, s5, s6
    s_lshl_b32 s5, s53, 7
    s_add_u32 s5, s5, s57
    s_lshl_b32 s5, s5, 11
    s_lshl_b32 s6, s52, 8
    s_add_u32 s48, s5, s6
L_lw_34:
    ds_read_b32 v32, v6 offset:44
    s_waitcnt lgkmcnt(0)
    v_readfirstlane_b32 s5, v32
    s_nop 0
    s_cmp_ge_u32 s5, 1
    s_cbranch_scc1 L_lwd_35
    s_sleep 1
    s_sub_u32 s4, s4, 1
    s_cbranch_scc1 L_end
    s_branch L_lw_34
L_lwd_35:
    ds_read_b64 v[32:33], v34
    s_waitcnt lgkmcnt(0)
    v_sub_f32 v32, v2, v32
    v_mul_f32 v32, s62, v32
    v_exp_f32 v32, v32
    s_nop 0
    v_mul_f32 v32, v32, v33
    v_mov_b32 v33, v32
    v_pk_mul_f32 v[16:17], v[16:17], v[32:33]
    v_pk_mul_f32 v[18:19], v[18:19], v[32:33]
    v_pk_mul_f32 v[20:21], v[20:21], v[32:33]
    v_pk_mul_f32 v[22:23], v[22:23], v[32:33]
    v_pk_mul_f32 v[24:25], v[24:25], v[32:33]
    v_pk_mul_f32 v[26:27], v[26:27], v[32:33]
    v_pk_mul_f32 v[28:29], v[28:29], v[32:33]
    v_pk_mul_f32 v[30:31], v[30:31], v[32:33]
    v_cvt_pk_bf16_f32 v8, v16, v17
    v_cvt_pk_bf16_f32 v9, v18, v19
    v_cvt_pk_bf16_f32 v10, v20, v21
    v_cvt_pk_bf16_f32 v11, v22, v23
    v_cvt_pk_bf16_f32 v12, v24, v25
    v_cvt_pk_bf16_f32 v13, v26, v27
    v_cvt_pk_bf16_f32 v14, v28, v29
    v_cvt_pk_bf16_f32 v15, v30, v31
    s_mov_b32 s64, 0x00ff00ff
    s_mov_b32 s65, 0x00ff00ff
    s_mov_b32 s66, 0xff00ff00
    s_mov_b32 s67, 0xff00ff00
    v_cndmask_b32 v32, 0, v8, s[64:65]
    v_cndmask_b32 v33, 0, v9, s[64:65]
    v_cndmask_b32 v34, 0, v10, s[64:65]
    v_cndmask_b32 v35, 0, v11, s[64:65]
    v_perm_b32 v28, v44, v40, s58
    v_perm_b32 v29, v52, v48, s58
    v_perm_b32 v30, v60, v56, s58
    v_perm_b32 v31, v68, v64, s58
    s_nop 1
    v_mfma_f32_16x16x32_bf16 v[16:19], v[28:31], v[32:35], 0
    v_perm_b32 v36, v44, v40, s59
    v_perm_b32 v37, v52, v48, s59
    v_perm_b32 v38, v60, v56, s59
    v_perm_b32 v39, v68, v64, s59
    s_nop 1
    v_mfma_f32_16x16x32_bf16 v[20:23], v[36:39], v[32:35], 0
    v_perm_b32 v28, v45, v41, s58
    v_perm_b32 v29, v53, v49, s58
    v_perm_b32 v30, v61, v57, s58
    v_perm_b32 v31, v69, v65, s58
    s_nop 1
    v_mfma_f32_16x16x32_bf16 v[24:27], v[28:31], v[32:35], 0
    v_perm_b32 v36, v45, v41, s59
    v_perm_b32 v37, v53, v49, s59
    v_perm_b32 v38, v61, v57, s59
    v_perm_b32 v39, v69, v65, s59
    s_nop 1
    v_mfma_f32_16x16x32_bf16 v[28:31], v[36:39], v[32:35], 0
    v_mov_b32_dpp v32, v32 row_ror:8 row_mask:0xf bank_mask:0xf
    v_mov_b32_dpp v33, v33 row_ror:8 row_mask:0xf bank_mask:0xf
    v_mov_b32_dpp v34, v34 row_ror:8 row_mask:0xf bank_mask:0xf
    v_mov_b32_dpp v35, v35 row_ror:8 row_mask:0xf bank_mask:0xf
    v_perm_b32 v36, v46, v42, s58
    v_perm_b32 v37, v54, v50, s58
    v_perm_b32 v38, v62, v58, s58
    v_perm_b32 v39, v70, v66, s58
    s_nop 1
    v_mfma_f32_16x16x32_bf16 v[16:19], v[36:39], v[32:35], v[16:19]
    v_perm_b32 v36, v46, v42, s59
    v_perm_b32 v37, v54, v50, s59
    v_perm_b32 v38, v62, v58, s59
    v_perm_b32 v39, v70, v66, s59
    s_nop 1
    v_mfma_f32_16x16x32_bf16 v[20:23], v[36:39], v[32:35], v[20:23]
    v_perm_b32 v36, v47, v43, s58
    v_perm_b32 v37, v55, v51, s58
    v_perm_b32 v38, v63, v59, s58
    v_perm_b32 v39, v71, v67, s58
    s_nop 1
    v_mfma_f32_16x16x32_bf16 v[24:27], v[36:39], v[32:35], v[24:27]
    v_perm_b32 v36, v47, v43, s59
    v_perm_b32 v37, v55, v51, s59
    v_perm_b32 v38, v63, v59, s59
    v_perm_b32 v39, v71, v67, s59
    s_nop 1
    v_mfma_f32_16x16x32_bf16 v[28:31], v[36:39], v[32:35], v[28:31]
    v_cndmask_b32 v36, 0, v8, s[66:67]
    v_cndmask_b32 v37, 0, v9, s[66:67]
    v_cndmask_b32 v38, 0, v10, s[66:67]
    v_cndmask_b32 v39, 0, v11, s[66:67]
    v_mov_b32_dpp v32, v36 row_ror:8 row_mask:0xf bank_mask:0xf
    v_mov_b32_dpp v33, v37 row_ror:8 row_mask:0xf bank_mask:0xf
    v_mov_b32_dpp v34, v38 row_ror:8 row_mask:0xf bank_mask:0xf
    v_mov_b32_dpp v35, v39 row_ror:8 row_mask:0xf bank_mask:0xf
    v_perm_b32 v40, v76, v72, s58
    v_perm_b32 v41, v84, v80, s58
    v_perm_b32 v42, v92, v88, s58
    v_perm_b32 v43, v100, v96, s58
    s_nop 1
    v_mfma_f32_16x16x32_bf16 v[16:19], v[40:43], v[32:35], v[16:19]
    v_perm_b32 v44, v76, v72, s59
    v_perm_b32 v45, v84, v80, s59
    v_perm_b32 v46, v92, v88, s59
    v_perm_b32 v47, v100, v96, s59
    s_nop 1
    v_mfma_f32_16x16x32_bf16 v[20:23], v[44:47], v[32:35], v[20:23]
    v_perm_b32 v48, v77, v73, s58
    v_perm_b32 v49, v85, v81, s58
    v_perm_b32 v50, v93, v89, s58
    v_perm_b32 v51, v101, v97, s58
    s_nop 1
    v_mfma_f32_16x16x32_bf16 v[24:27], v[48:51], v[32:35], v[24:27]
    v_perm_b32 v52, v77, v73, s59
    v_perm_b32 v53, v85, v81, s59
    v_perm_b32 v54, v93, v89, s59
    v_perm_b32 v55, v101, v97, s59
    s_nop 1
    v_mfma_f32_16x16x32_bf16 v[28:31], v[52:55], v[32:35], v[28:31]
    v_perm_b32 v40, v78, v74, s58
    v_perm_b32 v41, v86, v82, s58
    v_perm_b32 v42, v94, v90, s58
    v_perm_b32 v43, v102, v98, s58
    s_nop 1
    v_mfma_f32_16x16x32_bf16 v[16:19], v[40:43], v[36:39], v[16:19]
    v_perm_b32 v44, v78, v74, s59
    v_perm_b32 v45, v86, v82, s59
    v_perm_b32 v46, v94, v90, s59
    v_perm_b32 v47, v102, v98, s59
    s_nop 1
    v_mfma_f32_16x16x32_bf16 v[20:23], v[44:47], v[36:39], v[20:23]
    v_perm_b32 v48, v79, v75, s58
    v_perm_b32 v49, v87, v83, s58
    v_perm_b32 v50, v95, v91, s58
    v_perm_b32 v51, v103, v99, s58
    s_nop 1
    v_mfma_f32_16x16x32_bf16 v[24:27], v[48:51], v[36:39], v[24:27]
    v_perm_b32 v52, v79, v75, s59
    v_perm_b32 v53, v87, v83, s59
    v_perm_b32 v54, v95, v91, s59
    v_perm_b32 v55, v103, v99, s59
    s_nop 1
    v_mfma_f32_16x16x32_bf16 v[28:31], v[52:55], v[36:39], v[28:31]
    v_cndmask_b32 v32, 0, v12, s[64:65]
    v_cndmask_b32 v33, 0, v13, s[64:65]
    v_cndmask_b32 v34, 0, v14, s[64:65]
    v_cndmask_b32 v35, 0, v15, s[64:65]
    v_mov_b32_dpp v36, v32 row_ror:8 row_mask:0xf bank_mask:0xf
    v_mov_b32_dpp v37, v33 row_ror:8 row_mask:0xf bank_mask:0xf
    v_mov_b32_dpp v38, v34 row_ror:8 row_mask:0xf bank_mask:0xf
    v_mov_b32_dpp v39, v35 row_ror:8 row_mask:0xf bank_mask:0xf
    v_perm_b32 v40, v108, v104, s58
    v_perm_b32 v41, v116, v112, s58
    v_perm_b32 v42, v124, v120, s58
    v_perm_b32 v43, v132, v128, s58
    s_nop 1
    v_mfma_f32_16x16x32_bf16 v[16:19], v[40:43], v[32:35], v[16:19]
    v_perm_b32 v44, v108, v104, s59
    v_perm_b32 v45, v116, v112, s59
    v_perm_b32 v46, v124, v120, s59
    v_perm_b32 v47, v132, v128, s59
    s_nop 1
    v_mfma_f32_16x16x32_bf16 v[20:23], v[44:47], v[32:35], v[20:23]
    v_perm_b32 v48, v109, v105, s58
    v_perm_b32 v49, v117, v113, s58
    v_perm_b32 v50, v125, v121, s58
    v_perm_b32 v51, v133, v129, s58
    s_nop 1
    v_mfma_f32_16x16x32_bf16 v[24:27], v[48:51], v[32:35], v[24:27]
    v_perm_b32 v52, v109, v105, s59
    v_perm_b32 v53, v117, v113, s59
    v_perm_b32 v54, v125, v121, s59
    v_perm_b32 v55, v133, v129, s59
    s_nop 1
    v_mfma_f32_16x16x32_bf16 v[28:31], v[52:55], v[32:35], v[28:31]
    v_perm_b32 v40, v110, v106, s58
    v_perm_b32 v41, v118, v114, s58
    v_perm_b32 v42, v126, v122, s58
    v_perm_b32 v43, v134, v130, s58
    s_nop 1
    v_mfma_f32_16x16x32_bf16 v[16:19], v[40:43], v[36:39], v[16:19]
    v_perm_b32 v44, v110, v106, s59
    v_perm_b32 v45, v118, v114, s59
    v_perm_b32 v46, v126, v122, s59
    v_perm_b32 v47, v134, v130, s59
    s_nop 1
    v_mfma_f32_16x16x32_bf16 v[20:23], v[44:47], v[36:39], v[20:23]
    v_perm_b32 v48, v111, v107, s58
    v_perm_b32 v49, v119, v115, s58
    v_perm_b32 v50, v127, v123, s58
    v_perm_b32 v51, v135, v131, s58
    s_nop 1
    v_mfma_f32_16x16x32_bf16 v[24:27], v[48:51], v[36:39], v[24:27]
    v_perm_b32 v52, v111, v107, s59
    v_perm_b32 v53, v119, v115, s59
    v_perm_b32 v54, v127, v123, s59
    v_perm_b32 v55, v135, v131, s59
    s_nop 1
    v_mfma_f32_16x16x32_bf16 v[28:31], v[52:55], v[36:39], v[28:31]
    s_add_u32 s5, s56, 32768
    v_add_u32 v3, s5, v3
    v_cndmask_b32 v36, 0, v12, s[66:67]
    v_cndmask_b32 v37, 0, v13, s[66:67]
    v_cndmask_b32 v38, 0, v14, s[66:67]
    v_cndmask_b32 v39, 0, v15, s[66:67]
    v_mov_b32_dpp v32, v36 row_ror:8 row_mask:0xf bank_mask:0xf
    v_mov_b32_dpp v33, v37 row_ror:8 row_mask:0xf bank_mask:0xf
    v_mov_b32_dpp v34, v38 row_ror:8 row_mask:0xf bank_mask:0xf
    v_mov_b32_dpp v35, v39 row_ror:8 row_mask:0xf bank_mask:0xf
    v_perm_b32 v72, v140, v136, s58
    v_perm_b32 v76, v140, v136, s59
    v_perm_b32 v80, v141, v137, s58
    v_perm_b32 v84, v141, v137, s59
    v_perm_b32 v88, v142, v138, s58
    v_perm_b32 v92, v142, v138, s59
    v_perm_b32 v96, v143, v139, s58
    v_perm_b32 v100, v143, v139, s59
    s_waitcnt vmcnt(4)
    s_add_u32 m0, s56, 81920
    s_add_u32 s50, s46, 0
    buffer_load_dwordx4 v5, s[16:19], s50 offen nt lds
    s_add_u32 m0, s56, 82944
    s_add_u32 s50, s46, 8192
    buffer_load_dwordx4 v5, s[16:19], s50 offen nt lds
    v_xor_b32 v5, 0x80, v5
    v_perm_b32 v73, v148, v144, s58
    v_perm_b32 v77, v148, v144, s59
    v_perm_b32 v81, v149, v145, s58
    v_perm_b32 v85, v149, v145, s59
    v_perm_b32 v89, v150, v146, s58
    v_perm_b32 v93, v150, v146, s59
    v_perm_b32 v97, v151, v147, s58
    v_perm_b32 v101, v151, v147, s59
    s_waitcnt vmcnt(4)
    s_add_u32 m0, s56, 83968
    s_add_u32 s50, s46, 16384
    buffer_load_dwordx4 v5, s[16:19], s50 offen nt lds
    v_perm_b32 v74, v156, v152, s58
    v_perm_b32 v78, v156, v152, s59
    v_perm_b32 v82, v157, v153, s58
    v_perm_b32 v86, v157, v153, s59
    v_perm_b32 v90, v158, v154, s58
    v_perm_b32 v94, v158, v154, s59
    v_perm_b32 v98, v159, v155, s58
    v_perm_b32 v102, v159, v155, s59
    s_waitcnt vmcnt(3)
    v_perm_b32 v75, v164, v160, s58
    v_perm_b32 v91, v166, v162, s58
    v_perm_b32 v79, v164, v160, s59
    v_mfma_f32_16x16x32_bf16 v[16:19], v[72:75], v[32:35], v[16:19]
    v_perm_b32 v95, v166, v162, s59
    v_mfma_f32_16x16x32_bf16 v[16:19], v[88:91], v[36:39], v[16:19]
    v_perm_b32 v83, v165, v161, s58
    v_mfma_f32_16x16x32_bf16 v[20:23], v[76:79], v[32:35], v[20:23]
    v_perm_b32 v99, v167, v163, s58
    v_mfma_f32_16x16x32_bf16 v[20:23], v[92:95], v[36:39], v[20:23]
    v_perm_b32 v87, v165, v161, s59
    v_mfma_f32_16x16x32_bf16 v[24:27], v[80:83], v[32:35], v[24:27]
    v_perm_b32 v103, v167, v163, s59
    v_mfma_f32_16x16x32_bf16 v[24:27], v[96:99], v[36:39], v[24:27]
    v_mfma_f32_16x16x32_bf16 v[28:31], v[84:87], v[32:35], v[28:31]
    v_mfma_f32_16x16x32_bf16 v[28:31], v[100:103], v[36:39], v[28:31]
    ds_write_b128 v3, v[16:19] offset:0
    s_nop 0
    ds_write_b128 v3, v[20:23] offset:1024
    s_nop 2
    ds_write_b128 v3, v[24:27] offset:2048
    s_nop 0
    ds_write_b128 v3, v[28:31] offset:3072
    s_waitcnt lgkmcnt(0)
    s_barrier
L_lw_36:
    ds_read_b32 v32, v6 offset:68
    s_waitcnt lgkmcnt(0)
    v_readfirstlane_b32 s5, v32
    s_nop 0
    s_cmp_ge_u32 s5, 4
    s_cbranch_scc1 L_lwd_37
    s_sub_u32 s4, s4, 1
    s_cbranch_scc1 L_end
    s_branch L_lw_36
L_lwd_37:
    s_add_u32 m0, s56, 84992
    s_add_u32 s50, s46, 24576
    s_waitcnt vmcnt(2)
    buffer_load_dwordx4 v5, s[16:19], s50 offen nt lds
    v_xor_b32 v5, 0x80, v5
    s_add_u32 m0, s56, 114688
    s_add_u32 s50, s47, 0
    s_waitcnt vmcnt(2)
    buffer_load_dwordx4 v4, s[20:23], s50 offen nt lds
    s_add_u32 m0, s56, 115712
    s_add_u32 s50, s47, 28672
    s_waitcnt vmcnt(2)
    buffer_load_dwordx4 v4, s[20:23], s50 offen nt lds
    v_xor_b32 v4, 0x80, v4
    s_add_u32 m0, s56, 116736
    s_add_u32 s50, s47, 57344
    s_waitcnt vmcnt(2)
    s_mov_b64 exec, 1
    ds_add_u32 v6, v7 offset:16
    s_mov_b64 exec, -1
    buffer_load_dwordx4 v4, s[20:23], s50 offen nt lds
    s_mov_b64 exec, 1
    ds_add_u32 v6, v7 offset:96
    s_mov_b64 exec, -1
    s_add_u32 m0, s56, 117760
    s_add_u32 s50, s47, 86016
    s_waitcnt vmcnt(2)
    buffer_load_dwordx4 v4, s[20:23], s50 offen nt lds
    v_xor_b32 v4, 0x80, v4
    s_add_u32 m0, s56, 0
    s_add_u32 s50, s47, 0
    s_waitcnt vmcnt(2)
    buffer_load_dwordx4 v4, s[24:27], s50 offen nt lds
    s_add_u32 m0, s56, 1024
    s_add_u32 s50, s47, 28672
    s_waitcnt vmcnt(2)
    buffer_load_dwordx4 v4, s[24:27], s50 offen nt lds
    v_xor_b32 v4, 0x80, v4
    s_add_u32 m0, s56, 2048
    s_add_u32 s50, s47, 57344
    s_waitcnt vmcnt(2)
    s_mov_b64 exec, 1
    ds_add_u32 v6, v7 offset:20
    s_mov_b64 exec, -1
    buffer_load_dwordx4 v4, s[24:27], s50 offen nt lds
    s_add_u32 m0, s56, 3072
    s_add_u32 s50, s47, 86016
    s_waitcnt vmcnt(2)
    buffer_load_dwordx4 v4, s[24:27], s50 offen nt lds
    v_xor_b32 v4, 0x80, v4
    s_mov_b64 exec, 1
    ds_add_u32 v6, v7 offset:88
    s_mov_b64 exec, -1
    s_add_u32 m0, s56, 32768
    s_add_u32 s50, s48, 0
    s_waitcnt vmcnt(2)
    buffer_load_dwordx4 v5, s[28:31], s50 offen nt lds
    s_add_u32 m0, s56, 33792
    s_add_u32 s50, s48, 8192
    s_waitcnt vmcnt(2)
    buffer_load_dwordx4 v5, s[28:31], s50 offen nt lds
    v_xor_b32 v5, 0x80, v5
    s_add_u32 m0, s56, 34816
    s_add_u32 s50, s48, 16384
    s_waitcnt vmcnt(2)
    s_mov_b64 exec, 1
    ds_add_u32 v6, v7 offset:24
    s_mov_b64 exec, -1
    buffer_load_dwordx4 v5, s[28:31], s50 offen nt lds
    s_add_u32 m0, s56, 35840
    s_add_u32 s50, s48, 24576
    s_waitcnt vmcnt(2)
    buffer_load_dwordx4 v5, s[28:31], s50 offen nt lds
    v_xor_b32 v5, 0x80, v5
    s_mov_b64 exec, 1
    ds_add_u32 v6, v7 offset:92
    s_mov_b64 exec, -1
    s_waitcnt vmcnt(0)
    s_endpgm
L_cwave:
    s_setprio 3
    s_sub_u32 s28, s3, 8
    v_subrev_u32 v0, 512, v0
    v_mov_b32 v2, 147456
    v_mov_b32 v3, 1
    v_mov_b32 v16, 0
    v_lshlrev_b32 v17, 2, v1
    v_add_u32 v17, 147456, v17
    ds_write_b32 v17, v16
    v_mov_b32 v20, -1
    v_mov_b32 v21, -1
    v_mov_b32 v22, -1
    v_mov_b32 v23, -1
    ds_write_b32 v17, v20 offset:2560
    ds_write_b32 v17, v20 offset:2816
    ds_write_b32 v17, v20 offset:4352
    ds_write_b32 v17, v20 offset:4672
    s_mul_i32 s29, s2, 10112
    s_and_b32 s30, s2, 7
    s_lshr_b32 s31, s2, 3
    v_lshlrev_b32 v7, 4, v1
    v_lshlrev_b32 v8, 1, v1
    v_lshlrev_b32 v17, 5, v1
    s_lshl_b32 s32, s30, 7
    s_lshl_b32 s35, s28, 5
    s_add_u32 s32, s32, s35
    s_waitcnt lgkmcnt(0)
    s_mov_b64 s[8:9], s[94:95]
    s_mov_b32 s10, 268435456
    s_mov_b32 s11, 0x20000
    s_mov_b64 s[16:17], s[68:69]
    s_mov_b32 s18, 2048
    s_mov_b32 s19, 0x20000
    s_mov_b64 s[20:21], s[86:87]
    s_mov_b32 s22, 2048
    s_mov_b32 s23, 0x20000
    s_mov_b64 s[24:25], s[90:91]
    s_mov_b32 s26, 2048
    s_mov_b32 s27, 0x20000
    s_mov_b32 s5, 8388608
    buffer_load_dword v14, off, s[8:11], s5 sc1
    s_lshr_b32 s5, s2, 4
    s_lshl_b32 s5, s5, 7
    buffer_load_ushort v16, v8, s[20:23], s5 offen
    buffer_load_dwordx4 v[104:107], v17, s[16:19], 0 offen
    buffer_load_dwordx4 v[108:111], v17, s[16:19], 0 offen offset:16
    v_and_b32 v13, 7, v1
    v_lshlrev_b32 v13, 2, v13
    v_bfe_u32 v18, v1, 4, 1
    v_lshl_add_u32 v13, v18, 1, v13
    v_lshrrev_b32 v18, 5, v1
    v_add_lshl_u32 v13, v13, v18, 1
    s_lshl_b32 s5, s32, 1
    buffer_load_ushort v10, v13, s[16:19], s5 offen
    s_and_b32 s80, s2, 3
    s_lshl_b32 s80, s80, 12
    s_add_u32 s80, s80, 6422528
    s_and_b32 s81, s2, 0xfc
    s_lshl_b32 s81, s81, 4
    s_add_u32 s81, s81, s80
    s_cmp_gt_u32 s28, 1
    s_cbranch_scc1 L_clr_done
    s_cmp_eq_u32 s28, 0
    s_cselect_b32 s5, s29, s81
    s_cselect_b64 exec, -1, 15
    buffer_store_dwordx4 v[20:23], v7, s[8:11], s5 offen sc1
L_clr_done:
    s_mov_b64 exec, -1
    s_barrier
    v_lshrrev_b32 v24, 4, v1
    v_and_b32 v25, 15, v1
    v_lshlrev_b32 v5, 6, v25
    v_lshl_add_u32 v5, v24, 4, v5
    v_lshlrev_b32 v6, 4, v24
    v_add_u32 v6, 147456, v6
    v_bfe_u32 v26, v1, 2, 2
    v_lshl_add_u32 v27, v24, 3, v26
    v_lshlrev_b32 v4, 8, v27
    v_and_b32 v28, 3, v1
    v_lshl_add_u32 v4, v28, 3, v4
    v_and_b32 v28, 1, v24
    v_lshl_add_u32 v28, v28, 2, v26
    s_lshl_b32 s5, s28, 1
    v_xor_b32 v28, s5, v28
    v_lshl_add_u32 v4, v28, 5, v4
    s_mov_b32 s33, 0x3fb8aa3b
    s_mov_b32 s38, 0xffff0000
    s_waitcnt vmcnt(0)
    s_mov_b64 exec, 1
    ds_add_u32 v2, v3 offset:48
    s_mov_b64 exec, -1
    v_readfirstlane_b32 s5, v14
    s_nop 0
    s_add_u32 s6, s5, 0x7f4a7c15
    s_mul_i32 s6, s6, 0x9e3779b1
    s_lshr_b32 s7, s6, 15
    s_xor_b32 s6, s6, s7
    s_mul_i32 s6, s6, 0x85ebca6b
    s_lshr_b32 s7, s6, 13
    s_xor_b32 s6, s6, s7
    s_mul_i32 s6, s6, 0xc2b2ae35
    s_lshr_b32 s7, s6, 16
    s_xor_b32 s6, s6, s7
    s_and_b32 s7, s6, 0xff
    s_cselect_b32 s7, 0, 0x5b
    s_or_b32 s6, s6, s7
    s_and_b32 s7, s6, 0xff00
    s_cselect_b32 s7, 0, 0x5b00
    s_or_b32 s6, s6, s7
    s_and_b32 s7, s6, 0xff0000
    s_cselect_b32 s7, 0, 0x5b0000
    s_or_b32 s6, s6, s7
    s_and_b32 s7, s6, 0xff000000
    s_cselect_b32 s7, 0, 0x5b000000
    s_or_b32 s6, s6, s7
    s_xor_b32 s5, s5, s6
    s_bfe_u32 s76, s5, 0x80000
    s_bfe_u32 s77, s5, 0x80008
    s_bfe_u32 s78, s5, 0x80010
    s_bfe_u32 s79, s5, 0x80018
    v_mov_b32 v14, s5
    v_lshlrev_b32 v16, 16, v16
    v_max_f32 v29, 0xc2ae0000, v16
    v_min_f32 v29, 0x42c80000, v29
    v_mul_f32 v17, s33, v29
    v_fma_f32 v18, v29, s33, -v17
    v_mov_b32 v19, 0x32a57060
    v_fmac_f32 v18, v29, v19
    v_exp_f32 v17, -v17
    v_mul_f32 v18, 0xbf317218, v18
    v_fma_f32 v17, v17, v18, v17
    v_add_f32 v17, 1.0, v17
    v_rcp_f32 v18, v17
    s_nop 0
    v_mul_f32 v19, v16, v18
    v_fma_f32 v29, -v19, v17, v16
    v_fmac_f32 v19, v29, v18
    v_cvt_pk_bf16_f32 v19, 0, v19
    s_lshl_b32 s5, s28, 7
    s_add_u32 s6, s5, 150528
    v_add_u32 v17, s6, v8
    ds_write_b16_d16_hi v17, v19
    v_add_u32 v17, s5, v6
    s_waitcnt lgkmcnt(0)
    ds_read_b128 v[24:27], v17 offset:3072
    ds_read_b128 v[28:31], v17 offset:3136
    v_lshlrev_b32 v112, 16, v104
    v_and_b32 v113, 0xffff0000, v104
    v_lshlrev_b32 v114, 16, v105
    v_and_b32 v115, 0xffff0000, v105
    v_lshlrev_b32 v116, 16, v106
    v_and_b32 v117, 0xffff0000, v106
    v_lshlrev_b32 v118, 16, v107
    v_and_b32 v119, 0xffff0000, v107
    v_lshlrev_b32 v120, 16, v108
    v_and_b32 v121, 0xffff0000, v108
    v_lshlrev_b32 v122, 16, v109
    v_and_b32 v123, 0xffff0000, v109
    v_lshlrev_b32 v124, 16, v110
    v_and_b32 v125, 0xffff0000, v110
    v_lshlrev_b32 v126, 16, v111
    v_and_b32 v127, 0xffff0000, v111
    v_readfirstlane_b32 s36, v112
    s_nop 0
    s_mov_b32 s37, s36
    v_pk_add_f32 v[112:113], v[112:113], s[36:37] neg_lo:[0,1] neg_hi:[0,1]
    v_pk_add_f32 v[114:115], v[114:115], s[36:37] neg_lo:[0,1] neg_hi:[0,1]
    v_pk_add_f32 v[116:117], v[116:117], s[36:37] neg_lo:[0,1] neg_hi:[0,1]
    v_pk_add_f32 v[118:119], v[118:119], s[36:37] neg_lo:[0,1] neg_hi:[0,1]
    v_pk_add_f32 v[120:121], v[120:121], s[36:37] neg_lo:[0,1] neg_hi:[0,1]
    v_pk_add_f32 v[122:123], v[122:123], s[36:37] neg_lo:[0,1] neg_hi:[0,1]
    v_pk_add_f32 v[124:125], v[124:125], s[36:37] neg_lo:[0,1] neg_hi:[0,1]
    v_pk_add_f32 v[126:127], v[126:127], s[36:37] neg_lo:[0,1] neg_hi:[0,1]
    v_pk_mul_f32 v[20:21], v[112:113], v[112:113]
    v_pk_add_f32 v[18:19], v[112:113], v[114:115]
    v_pk_fma_f32 v[20:21], v[114:115], v[114:115], v[20:21]
    v_pk_add_f32 v[18:19], v[18:19], v[116:117]
    v_pk_fma_f32 v[20:21], v[116:117], v[116:117], v[20:21]
    v_pk_add_f32 v[18:19], v[18:19], v[118:119]
    v_pk_fma_f32 v[20:21], v[118:119], v[118:119], v[20:21]
    v_pk_add_f32 v[18:19], v[18:19], v[120:121]
    v_pk_fma_f32 v[20:21], v[120:121], v[120:121], v[20:21]
    v_pk_add_f32 v[18:19], v[18:19], v[122:123]
    v_pk_fma_f32 v[20:21], v[122:123], v[122:123], v[20:21]
    v_pk_add_f32 v[18:19], v[18:19], v[124:125]
    v_pk_fma_f32 v[20:21], v[124:125], v[124:125], v[20:21]
    v_pk_add_f32 v[18:19], v[18:19], v[126:127]
    v_pk_fma_f32 v[20:21], v[126:127], v[126:127], v[20:21]
    v_add_f32 v18, v18, v19
    v_add_f32 v20, v20, v21
    s_nop 1
    v_permlane32_swap_b32 v18, v20
    v_add_f32 v18, v18, v20
    v_mov_b32 v22, v18
    s_nop 1
    v_permlane16_swap_b32 v18, v22
    v_add_f32 v18, v18, v22
    s_nop 1
    v_add_f32_dpp v18, v18, v18 row_ror:8 row_mask:0xf bank_mask:0xf
    s_nop 1
    v_add_f32_dpp v18, v18, v18 row_ror:4 row_mask:0xf bank_mask:0xf
    s_nop 1
    v_add_f32_dpp v18, v18, v18 row_ror:2 row_mask:0xf bank_mask:0xf
    s_nop 1
    v_add_f32_dpp v18, v18, v18 row_ror:1 row_mask:0xf bank_mask:0xf
    v_mul_f32 v18, 0x3a800000, v18
    v_mov_b32 v20, v18
    s_nop 1
    v_permlane32_swap_b32 v18, v20
    v_fma_f32 v20, -v18, v18, v20
    v_add_f32 v18, s36, v18
    v_max_f32 v20, 0, v20
    v_cvt_pk_bf16_f32 v16, 0, v18
    v_cvt_pk_bf16_f32 v20, 0, v20
    v_add_f32 v20, 0x3727c5ac, v20
    v_cvt_pk_bf16_f32 v20, 0, v20
    v_sqrt_f32 v20, v20
    s_nop 0
    v_cvt_pk_bf16_f32 v20, 0, v20
    v_rcp_f32 v17, v20
    v_lshlrev_b32 v10, 16, v10
    v_sub_f32 v10, v10, v16
    v_cvt_pk_bf16_f32 v10, 0, v10
    v_mul_f32 v10, v10, v17
    v_cvt_pk_bf16_f32 v10, 0, v10
L_lw_38:
    ds_read_b32 v17, v2 offset:48
    s_waitcnt lgkmcnt(0)
    v_readfirstlane_b32 s5, v17
    s_nop 0
    s_cmp_ge_u32 s5, 4
    s_cbranch_scc1 L_lwd_39
    s_sub_u32 s4, s4, 1
    s_cbranch_scc1 L_end
    s_branch L_lw_38
L_lwd_39:
    s_getreg_b32 s14, hwreg(HW_REG_XCC_ID)
    s_cmp_lg_u32 s28, 1
    s_cbranch_scc1 L_xc_done
    v_mov_b32 v16, s14
    v_mov_b32 v17, v14
    s_lshl_b32 s5, s30, 8
    s_and_b32 s6, s2, 0xf8
    s_add_u32 s5, s5, s6
    s_add_u32 s5, s5, 6356992
    s_mov_b64 exec, 1
    buffer_store_dwordx2 v[16:17], off, s[8:11], s5 sc1
    s_mov_b64 exec, -1
L_xc_done:
    s_mov_b32 s39, 0
L_lw_40:
    ds_read_b32 v16, v2 offset:0
    s_waitcnt lgkmcnt(0)
    v_readfirstlane_b32 s5, v16
    s_nop 0
    s_cmp_ge_u32 s5, 8
    s_cbranch_scc1 L_lwd_41
    s_sleep 1
    s_sub_u32 s4, s4, 1
    s_cbranch_scc1 L_end
    s_branch L_lw_40
L_lwd_41:
    v_add_u32 v20, 0, v4
    v_xor_b32 v21, 32, v20
    ds_read_b64_tr_b16 v[104:105], v20 offset:0
    ds_read_b64_tr_b16 v[106:107], v20 offset:1024
    ds_read_b64_tr_b16 v[108:109], v20 offset:8192
    ds_read_b64_tr_b16 v[110:111], v20 offset:9216
    ds_read_b64_tr_b16 v[112:113], v21 offset:0
    ds_read_b64_tr_b16 v[114:115], v21 offset:1024
    ds_read_b64_tr_b16 v[116:117], v21 offset:8192
    ds_read_b64_tr_b16 v[118:119], v21 offset:9216
    s_waitcnt lgkmcnt(0)
    s_mul_i32 s5, s28, 128
    s_add_u32 s5, s5, s29
    s_add_u32 s5, s5, 512
    v_mfma_f32_16x16x32_bf16 v[120:123], v[104:107], v[24:27], 0
    v_mfma_f32_16x16x32_bf16 v[120:123], v[108:111], v[28:31], v[120:123]
    v_mfma_f32_16x16x32_bf16 v[124:127], v[112:115], v[24:27], 0
    v_mfma_f32_16x16x32_bf16 v[124:127], v[116:119], v[28:31], v[124:127]
    s_mov_b32 exec_lo, 0x10001
    s_mov_b32 exec_hi, 0x10001
    s_nop 3
    v_mov_b32 v128, v120
    v_mov_b32 v129, v121
    v_mov_b32 v130, v122
    v_mov_b32 v131, v123
    s_mov_b32 exec_lo, 0x20002
    s_mov_b32 exec_hi, 0x20002
    v_mov_b32 v128, v124
    v_mov_b32 v129, v125
    v_mov_b32 v130, v126
    v_mov_b32 v131, v127
    s_mov_b32 exec_lo, 0x30003
    s_mov_b32 exec_hi, 0x30003
    buffer_store_dwordx4 v[128:131], v5, s[8:11], s5 offen sc1
    s_mov_b64 exec, -1
    v_mov_b32 v23, 0xffffff00
    v_lshrrev_b32 v16, 3, v1
    v_mul_u32_u24 v7, 161792, v16
    v_and_b32 v16, 7, v1
    v_lshl_add_u32 v7, v16, 4, v7
    s_mul_i32 s5, s30, 10112
    s_lshl_b32 s7, s28, 7
    s_add_u32 s5, s5, s7
    v_add_u32 v7, s5, v7
    v_lshl_add_u32 v15, v1, 3, s30
    s_and_b32 s5, s2, 3
    s_lshl_b32 s5, s5, 6
    s_lshl_b32 s6, s28, 4
    s_add_u32 s5, s5, s6
    v_and_b32 v16, 15, v1
    s_mov_b32 exec_lo, 0
    v_add_u32 v15, s5, v16
    s_mov_b32 exec_lo, -1
    v_and_b32 v16, 7, v15
    v_and_b32 v15, 0xf8, v15
    v_lshl_add_u32 v15, v16, 8, v15
L_lw_42:
    ds_read_b32 v20, v2 offset:4
    s_waitcnt lgkmcnt(0)
    v_readfirstlane_b32 s5, v20
    s_nop 0
    s_cmp_ge_u32 s5, 8
    s_cbranch_scc1 L_lwd_43
    s_sleep 1
    s_sub_u32 s4, s4, 1
    s_cbranch_scc1 L_end
    s_branch L_lw_42
L_lwd_43:
    v_add_u32 v20, 49152, v4
    v_xor_b32 v21, 32, v20
    ds_read_b64_tr_b16 v[136:137], v20 offset:0
    ds_read_b64_tr_b16 v[138:139], v20 offset:1024
    ds_read_b64_tr_b16 v[140:141], v20 offset:8192
    ds_read_b64_tr_b16 v[142:143], v20 offset:9216
    ds_read_b64_tr_b16 v[144:145], v20 offset:16384
    ds_read_b64_tr_b16 v[146:147], v20 offset:17408
    ds_read_b64_tr_b16 v[148:149], v20 offset:24576
    ds_read_b64_tr_b16 v[150:151], v20 offset:25600
    ds_read_b64_tr_b16 v[152:153], v21 offset:0
    ds_read_b64_tr_b16 v[154:155], v21 offset:1024
    ds_read_b64_tr_b16 v[156:157], v21 offset:8192
    ds_read_b64_tr_b16 v[158:159], v21 offset:9216
    ds_read_b64_tr_b16 v[160:161], v21 offset:16384
    ds_read_b64_tr_b16 v[162:163], v21 offset:17408
    ds_read_b64_tr_b16 v[164:165], v21 offset:24576
    ds_read_b64_tr_b16 v[166:167], v21 offset:25600
L_lw_44:
    ds_read_b32 v16, v2 offset:8
    s_waitcnt lgkmcnt(0)
    v_readfirstlane_b32 s5, v16
    s_nop 0
    s_cmp_ge_u32 s5, 8
    s_cbranch_scc1 L_lwd_45
    s_sleep 1
    s_sub_u32 s4, s4, 1
    s_cbranch_scc1 L_end
    s_branch L_lw_44
L_lwd_45:
    v_add_u32 v20, 16384, v4
    v_xor_b32 v21, 32, v20
    ds_read_b64_tr_b16 v[104:105], v20 offset:0
    ds_read_b64_tr_b16 v[106:107], v20 offset:1024
    ds_read_b64_tr_b16 v[108:109], v20 offset:8192
    ds_read_b64_tr_b16 v[110:111], v20 offset:9216
    ds_read_b64_tr_b16 v[112:113], v21 offset:0
    ds_read_b64_tr_b16 v[114:115], v21 offset:1024
    ds_read_b64_tr_b16 v[116:117], v21 offset:8192
    ds_read_b64_tr_b16 v[118:119], v21 offset:9216
    s_waitcnt lgkmcnt(0)
    s_mul_i32 s5, s28, 128
    s_add_u32 s5, s5, s29
    s_add_u32 s5, s5, 2048
    v_mfma_f32_16x16x32_bf16 v[120:123], v[104:107], v[24:27], 0
    v_mfma_f32_16x16x32_bf16 v[120:123], v[108:111], v[28:31], v[120:123]
    v_mfma_f32_16x16x32_bf16 v[124:127], v[112:115], v[24:27], 0
    v_mfma_f32_16x16x32_bf16 v[124:127], v[116:119], v[28:31], v[124:127]
    s_mov_b32 exec_lo, 0x10001
    s_mov_b32 exec_hi, 0x10001
    s_nop 3
    v_and_or_b32 v128, v120, v23, s76
    v_and_or_b32 v129, v121, v23, s77
    v_and_or_b32 v130, v122, v23, s78
    v_and_or_b32 v131, v123, v23, s79
    s_mov_b32 exec_lo, 0x20002
    s_mov_b32 exec_hi, 0x20002
    v_and_or_b32 v128, v124, v23, s76
    v_and_or_b32 v129, v125, v23, s77
    v_and_or_b32 v130, v126, v23, s78
    v_and_or_b32 v131, v127, v23, s79
    s_mov_b32 exec_lo, 0x30003
    s_mov_b32 exec_hi, 0x30003
    buffer_store_dwordx4 v[128:131], v5, s[8:11], s5 offen sc1
    s_mov_b64 exec, -1
L_lw_46:
    ds_read_b32 v16, v2 offset:12
    s_waitcnt lgkmcnt(0)
    v_readfirstlane_b32 s5, v16
    s_nop 0
    s_cmp_ge_u32 s5, 8
    s_cbranch_scc1 L_lwd_47
    s_sleep 1
    s_sub_u32 s4, s4, 1
    s_cbranch_scc1 L_end
    s_branch L_lw_46
L_lwd_47:
    v_add_u32 v20, 32768, v4
    v_xor_b32 v21, 32, v20
    ds_read_b64_tr_b16 v[104:105], v20 offset:0
    ds_read_b64_tr_b16 v[106:107], v20 offset:1024
    ds_read_b64_tr_b16 v[108:109], v20 offset:8192
    ds_read_b64_tr_b16 v[110:111], v20 offset:9216
    ds_read_b64_tr_b16 v[112:113], v21 offset:0
    ds_read_b64_tr_b16 v[114:115], v21 offset:1024
    ds_read_b64_tr_b16 v[116:117], v21 offset:8192
    ds_read_b64_tr_b16 v[118:119], v21 offset:9216
    s_waitcnt lgkmcnt(0)
    s_mul_i32 s5, s28, 128
    s_add_u32 s5, s5, s29
    s_add_u32 s5, s5, 2560
    v_mfma_f32_16x16x32_bf16 v[120:123], v[104:107], v[24:27], 0
    v_mfma_f32_16x16x32_bf16 v[120:123], v[108:111], v[28:31], v[120:123]
    v_mfma_f32_16x16x32_bf16 v[124:127], v[112:115], v[24:27], 0
    v_mfma_f32_16x16x32_bf16 v[124:127], v[116:119], v[28:31], v[124:127]
    s_mov_b32 exec_lo, 0x10001
    s_mov_b32 exec_hi, 0x10001
    s_nop 3
    v_and_or_b32 v128, v120, v23, s76
    v_and_or_b32 v129, v121, v23, s77
    v_and_or_b32 v130, v122, v23, s78
    v_and_or_b32 v131, v123, v23, s79
    s_mov_b32 exec_lo, 0x20002
    s_mov_b32 exec_hi, 0x20002
    v_and_or_b32 v128, v124, v23, s76
    v_and_or_b32 v129, v125, v23, s77
    v_and_or_b32 v130, v126, v23, s78
    v_and_or_b32 v131, v127, v23, s79
    s_mov_b32 exec_lo, 0x30003
    s_mov_b32 exec_hi, 0x30003
    buffer_store_dwordx4 v[128:131], v5, s[8:11], s5 offen sc1
    s_mov_b64 exec, -1
    s_nop 0
    s_mov_b32 s5, 6356992
    buffer_load_dwordx2 v[72:73], v15, s[8:11], s5 offen sc1
    s_waitcnt vmcnt(0)
    s_branch L_gc_50
L_gd_49:
    v_cmp_ne_u32 vcc, s14, v72
    s_nop 0
    s_cmp_eq_u32 vcc_lo, 0
    s_cselect_b32 s15, 1, 0
L_lw_51:
    ds_read_b32 v20, v2 offset:52
    s_waitcnt lgkmcnt(0)
    v_readfirstlane_b32 s5, v20
    s_nop 0
    s_cmp_ge_u32 s5, 8
    s_cbranch_scc1 L_lwd_52
    s_sleep 1
    s_sub_u32 s4, s4, 1
    s_cbranch_scc1 L_end
    s_branch L_lw_51
L_lwd_52:
    s_nop 0
    s_mov_b32 s5, 512
    buffer_load_dwordx4 v[104:107], v7, s[8:11], s5 offen sc1
    s_mov_b32 s5, 1294848
    buffer_load_dwordx4 v[108:111], v7, s[8:11], s5 offen sc1
    s_mov_b32 s5, 81408
    buffer_load_dwordx4 v[112:115], v7, s[8:11], s5 offen sc1
    s_mov_b32 s5, 1375744
    buffer_load_dwordx4 v[116:119], v7, s[8:11], s5 offen sc1
    s_waitcnt vmcnt(3)
    v_max3_u32 v16, v104, v105, v106
    v_max_u32 v16, v16, v107
    s_waitcnt vmcnt(2)
    v_max3_u32 v16, v16, v108, v109
    v_max3_u32 v16, v16, v110, v111
    s_waitcnt vmcnt(1)
    v_max3_u32 v16, v16, v112, v113
    v_max3_u32 v16, v16, v114, v115
    s_waitcnt vmcnt(0)
    v_max3_u32 v16, v16, v116, v117
    v_max3_u32 v16, v16, v118, v119
    v_cmp_eq_u32 vcc, -1, v16
    s_cbranch_vccnz L_gc_55
L_gd_54:
    v_pk_add_f32 v[104:105], v[104:105], v[108:109]
    v_pk_add_f32 v[106:107], v[106:107], v[110:111]
    v_pk_add_f32 v[112:113], v[112:113], v[116:117]
    v_pk_add_f32 v[114:115], v[114:115], v[118:119]
    v_permlane32_swap_b32 v104, v105
    v_permlane32_swap_b32 v106, v107
    v_add_f32 v104, v104, v105
    v_add_f32 v106, v106, v107
    s_nop 1
    v_permlane16_swap_b32 v104, v106
    v_add_f32 v104, v104, v106
    s_nop 1
    v_add_f32_dpp v104, v104, v104 row_ror:8 row_mask:0xf bank_mask:0xf
    v_permlane32_swap_b32 v112, v113
    v_permlane32_swap_b32 v114, v115
    v_add_f32 v112, v112, v113
    v_add_f32 v114, v114, v115
    s_nop 1
    v_permlane16_swap_b32 v112, v114
    v_add_f32 v112, v112, v114
    s_nop 1
    v_add_f32_dpp v112, v112, v112 row_ror:8 row_mask:0xf bank_mask:0xf
    v_cvt_pk_bf16_f32 v104, 0, v104
    v_cvt_pk_bf16_f32 v112, 0, v112
    v_add_f32 v112, 1.0, v112
    v_cvt_pk_bf16_f32 v112, 0, v112
    v_mul_f32 v10, v10, v112
    v_cvt_pk_bf16_f32 v10, 0, v10
    v_add_f32 v10, v10, v104
    v_cvt_pk_bf16_f32 v10, 0, v10
    s_lshl_b32 s5, s28, 6
    s_add_u32 s5, s5, 149760
    v_add_u32 v8, s5, v13
    ds_write_b16_d16_hi v8, v10
    s_waitcnt lgkmcnt(0)
    s_mov_b64 exec, 1
    ds_add_u32 v2, v3 offset:36
    s_mov_b64 exec, -1
L_lw_56:
    ds_read_b32 v16, v2 offset:36
    s_waitcnt lgkmcnt(0)
    v_readfirstlane_b32 s5, v16
    s_nop 0
    s_cmp_ge_u32 s5, 4
    s_cbranch_scc1 L_lwd_57
    s_sub_u32 s4, s4, 1
    s_cbranch_scc1 L_end
    s_branch L_lw_56
L_lwd_57:
    ds_read_b128 v[24:27], v6 offset:2304
    ds_read_b128 v[28:31], v6 offset:2368
    ds_read_b128 v[32:35], v6 offset:2432
    ds_read_b128 v[36:39], v6 offset:2496
    s_waitcnt lgkmcnt(0)
    s_mul_i32 s5, s28, 128
    s_add_u32 s5, s5, s29
    s_add_u32 s5, s5, 0
    v_mfma_f32_16x16x32_bf16 v[104:107], v[136:139], v[24:27], 0
    v_mfma_f32_16x16x32_bf16 v[104:107], v[140:143], v[28:31], v[104:107]
    v_mfma_f32_16x16x32_bf16 v[104:107], v[144:147], v[32:35], v[104:107]
    v_mfma_f32_16x16x32_bf16 v[104:107], v[148:151], v[36:39], v[104:107]
    v_mfma_f32_16x16x32_bf16 v[108:111], v[152:155], v[24:27], 0
    v_mfma_f32_16x16x32_bf16 v[108:111], v[156:159], v[28:31], v[108:111]
    v_mfma_f32_16x16x32_bf16 v[108:111], v[160:163], v[32:35], v[108:111]
    v_mfma_f32_16x16x32_bf16 v[108:111], v[164:167], v[36:39], v[108:111]
    s_mov_b32 exec_lo, 0x10001
    s_mov_b32 exec_hi, 0x10001
    s_nop 1
    v_mov_b32 v112, v104
    v_mov_b32 v113, v105
    v_mov_b32 v114, v106
    v_mov_b32 v115, v107
    s_mov_b32 exec_lo, 0x20002
    s_mov_b32 exec_hi, 0x20002
    v_mov_b32 v112, v108
    v_mov_b32 v113, v109
    v_mov_b32 v114, v110
    v_mov_b32 v115, v111
    s_mov_b32 exec_lo, 0x30003
    s_mov_b32 exec_hi, 0x30003
    buffer_store_dwordx4 v[112:115], v5, s[8:11], s5 offen sc1
    s_mov_b64 exec, -1
    s_and_b32 s5, s2, 3
    s_lshl_b32 s5, s5, 3
    v_lshrrev_b32 v20, 5, v0
    v_add_u32 v20, s5, v20
    v_mul_u32_u24 v7, 80896, v20
    v_and_b32 v20, 31, v0
    v_lshl_add_u32 v7, v20, 4, v7
    v_lshlrev_b32 v18, 3, v0
    v_add_u32 v18, 147712, v18
L_lw_58:
    ds_read_b32 v20, v2 offset:56
    s_waitcnt lgkmcnt(0)
    v_readfirstlane_b32 s5, v20
    s_nop 0
    s_cmp_ge_u32 s5, 8
    s_cbranch_scc1 L_lwd_59
    s_sleep 1
    s_sub_u32 s4, s4, 1
    s_cbranch_scc1 L_end
    s_branch L_lw_58
L_lwd_59:
    s_nop 0
    buffer_load_dwordx4 v[72:75], v7, s[8:11], 0 offen sc1
    s_mov_b32 s5, 10112
    buffer_load_dwordx4 v[76:79], v7, s[8:11], s5 offen sc1
    s_mov_b32 s5, 20224
    buffer_load_dwordx4 v[80:83], v7, s[8:11], s5 offen sc1
    s_mov_b32 s5, 30336
    buffer_load_dwordx4 v[84:87], v7, s[8:11], s5 offen sc1
    s_mov_b32 s5, 40448
    buffer_load_dwordx4 v[88:91], v7, s[8:11], s5 offen sc1
    s_mov_b32 s5, 50560
    buffer_load_dwordx4 v[92:95], v7, s[8:11], s5 offen sc1
    s_mov_b32 s5, 60672
    buffer_load_dwordx4 v[96:99], v7, s[8:11], s5 offen sc1
    s_mov_b32 s5, 70784
    buffer_load_dwordx4 v[100:103], v7, s[8:11], s5 offen sc1
    s_waitcnt vmcnt(7)
    v_max3_u32 v16, v72, v73, v74
    v_max_u32 v16, v16, v75
    s_waitcnt vmcnt(6)
    v_max3_u32 v16, v16, v76, v77
    v_max3_u32 v16, v16, v78, v79
    s_waitcnt vmcnt(5)
    v_max3_u32 v16, v16, v80, v81
    v_max3_u32 v16, v16, v82, v83
    s_waitcnt vmcnt(4)
    v_max3_u32 v16, v16, v84, v85
    v_max3_u32 v16, v16, v86, v87
    s_waitcnt vmcnt(3)
    v_max3_u32 v16, v16, v88, v89
    v_max3_u32 v16, v16, v90, v91
    s_waitcnt vmcnt(2)
    v_max3_u32 v16, v16, v92, v93
    v_max3_u32 v16, v16, v94, v95
    s_waitcnt vmcnt(1)
    v_max3_u32 v16, v16, v96, v97
    v_max3_u32 v16, v16, v98, v99
    s_waitcnt vmcnt(0)
    v_max3_u32 v16, v16, v100, v101
    v_max3_u32 v16, v16, v102, v103
    v_cmp_eq_u32 vcc, -1, v16
    s_cbranch_vccnz L_gc_62
L_gd_61:
    v_pk_add_f32 v[72:73], v[72:73], v[76:77]
    v_pk_add_f32 v[74:75], v[74:75], v[78:79]
    v_pk_add_f32 v[80:81], v[80:81], v[84:85]
    v_pk_add_f32 v[82:83], v[82:83], v[86:87]
    v_pk_add_f32 v[88:89], v[88:89], v[92:93]
    v_pk_add_f32 v[90:91], v[90:91], v[94:95]
    v_pk_add_f32 v[96:97], v[96:97], v[100:101]
    v_pk_add_f32 v[98:99], v[98:99], v[102:103]
    v_pk_add_f32 v[72:73], v[72:73], v[80:81]
    v_pk_add_f32 v[74:75], v[74:75], v[82:83]
    v_pk_add_f32 v[88:89], v[88:89], v[96:97]
    v_pk_add_f32 v[90:91], v[90:91], v[98:99]
    v_pk_add_f32 v[72:73], v[72:73], v[88:89]
    v_pk_add_f32 v[74:75], v[74:75], v[90:91]
    v_cvt_pk_bf16_f32 v16, v72, v73
    v_cvt_pk_bf16_f32 v17, v74, v75
    ds_write_b64 v18, v[16:17]
    s_waitcnt lgkmcnt(0)
    s_mov_b64 exec, 1
    ds_add_u32 v2, v3 offset:32
    s_mov_b64 exec, -1
    s_add_u32 s5, s2, s28
    s_cmp_lg_u32 s5, 0
    s_cbranch_scc1 L_ep_done
    s_mov_b32 s5, 8388608
    s_mov_b64 exec, 1
    buffer_store_dword v14, off, s[8:11], s5 sc1
    s_mov_b64 exec, -1
L_ep_done:
    s_cmp_lg_u32 s28, 1
    s_cbranch_scc1 L_role_done
    s_lshr_b32 s36, s2, 3
    s_lshl_b32 s7, s30, 2
    s_lshr_b32 s7, 0x76352104, s7
    s_and_b32 s7, s7, 15
    s_add_u32 s7, s7, 24
    s_lshr_b32 s6, s36, 3
    s_mul_i32 s5, s30, 3
    s_add_u32 s5, s5, s6
    s_cmp_lt_u32 s6, 3
    s_cselect_b32 s5, s5, s7
    s_cmp_lt_u32 s6, 4
    s_cselect_b32 s5, s5, 28
    s_lshl_b32 s5, s5, 3
    s_and_b32 s6, s36, 7
    s_add_u32 s5, s5, s6
    s_add_u32 s5, s5, 1
    v_mov_b32 v16, s5
    s_mov_b64 exec, 1
    ds_write_b32 v2, v16 offset:72
    s_mov_b64 exec, -1
L_role_done:
    s_cmp_lg_u32 s28, 0
    s_cbranch_scc1 L_ml_pub
L_lw_63:
    ds_read_b32 v16, v2 offset:40
    s_waitcnt lgkmcnt(0)
    v_readfirstlane_b32 s5, v16
    s_nop 0
    s_cmp_ge_u32 s5, 8
    s_cbranch_scc1 L_lwd_64
    s_sleep 2
    s_sub_u32 s4, s4, 1
    s_cbranch_scc1 L_end
    s_branch L_lw_63
L_lwd_64:
    v_lshlrev_b32 v18, 3, v1
    v_add_u32 v19, 151040, v18
    ds_read_b64 v[16:17], v19
    s_waitcnt lgkmcnt(0)
    v_mov_b32 v20, v16
    s_nop 1
    v_max_f32_dpp v20, v20, v20 row_ror:8 row_mask:0xf bank_mask:0xf
    v_mov_b32 v22, v20
    s_nop 1
    v_permlane16_swap_b32 v20, v22
    v_max_f32 v20, v20, v22
    v_mov_b32 v22, v20
    s_nop 1
    v_permlane32_swap_b32 v20, v22
    v_max_f32 v20, v20, v22
    v_sub_f32 v16, v16, v20
    v_mul_f32 v16, s33, v16
    v_exp_f32 v16, v16
    s_nop 0
    v_mul_f32 v21, v16, v17
    s_nop 1
    v_add_f32_dpp v21, v21, v21 row_ror:8 row_mask:0xf bank_mask:0xf
    v_mov_b32 v22, v21
    s_nop 1
    v_permlane16_swap_b32 v21, v22
    v_add_f32 v21, v21, v22
    v_mov_b32 v22, v21
    s_nop 1
    v_permlane32_swap_b32 v21, v22
    v_add_f32 v21, v21, v22
    s_mov_b64 exec, 0xff
    buffer_store_dwordx2 v[20:21], v18, s[8:11], s81 offen sc1
    s_mov_b64 exec, -1
L_ml_pub:
    s_cmp_lg_u32 s28, 2
    s_cbranch_scc1 L_modf_done
    s_and_b32 s5, s2, 0xc4
    s_cmp_lg_u32 s5, 0xc4
    s_cbranch_scc1 L_modf_done
    s_bfe_u32 s36, s2, 0x30003
    s_and_b32 s37, s2, 3
    s_mul_i32 s5, s36, 10112
    s_lshl_b32 s6, s37, 7
    s_add_u32 s5, s5, s6
    v_lshrrev_b32 v16, 3, v1
    v_mul_u32_u24 v7, 161792, v16
    v_and_b32 v16, 7, v1
    v_lshl_add_u32 v7, v16, 4, v7
    v_add_u32 v7, s5, v7
    s_nop 0
    s_mov_b32 s5, 2048
    buffer_load_dwordx4 v[72:75], v7, s[8:11], s5 offen sc1
    s_mov_b32 s5, 1296384
    buffer_load_dwordx4 v[76:79], v7, s[8:11], s5 offen sc1
    s_mov_b32 s5, 82944
    buffer_load_dwordx4 v[80:83], v7, s[8:11], s5 offen sc1
    s_mov_b32 s5, 1377280
    buffer_load_dwordx4 v[84:87], v7, s[8:11], s5 offen sc1
    s_mov_b32 s5, 2560
    buffer_load_dwordx4 v[88:91], v7, s[8:11], s5 offen sc1
    s_mov_b32 s5, 1296896
    buffer_load_dwordx4 v[92:95], v7, s[8:11], s5 offen sc1
    s_mov_b32 s5, 83456
    buffer_load_dwordx4 v[96:99], v7, s[8:11], s5 offen sc1
    s_mov_b32 s5, 1377792
    buffer_load_dwordx4 v[100:103], v7, s[8:11], s5 offen sc1
    s_waitcnt vmcnt(7)
    v_xor_b32 v72, s76, v72
    v_xor_b32 v73, s77, v73
    v_xor_b32 v74, s78, v74
    v_xor_b32 v75, s79, v75
    v_or3_b32 v16, v72, v73, v74
    v_or_b32 v16, v16, v75
    s_waitcnt vmcnt(6)
    v_xor_b32 v76, s76, v76
    v_xor_b32 v77, s77, v77
    v_xor_b32 v78, s78, v78
    v_xor_b32 v79, s79, v79
    v_or3_b32 v16, v16, v76, v77
    v_or3_b32 v16, v16, v78, v79
    s_waitcnt vmcnt(5)
    v_xor_b32 v80, s76, v80
    v_xor_b32 v81, s77, v81
    v_xor_b32 v82, s78, v82
    v_xor_b32 v83, s79, v83
    v_or3_b32 v16, v16, v80, v81
    v_or3_b32 v16, v16, v82, v83
    s_waitcnt vmcnt(4)
    v_xor_b32 v84, s76, v84
    v_xor_b32 v85, s77, v85
    v_xor_b32 v86, s78, v86
    v_xor_b32 v87, s79, v87
    v_or3_b32 v16, v16, v84, v85
    v_or3_b32 v16, v16, v86, v87
    s_waitcnt vmcnt(3)
    v_xor_b32 v88, s76, v88
    v_xor_b32 v89, s77, v89
    v_xor_b32 v90, s78, v90
    v_xor_b32 v91, s79, v91
    v_or3_b32 v16, v16, v88, v89
    v_or3_b32 v16, v16, v90, v91
    s_waitcnt vmcnt(2)
    v_xor_b32 v92, s76, v92
    v_xor_b32 v93, s77, v93
    v_xor_b32 v94, s78, v94
    v_xor_b32 v95, s79, v95
    v_or3_b32 v16, v16, v92, v93
    v_or3_b32 v16, v16, v94, v95
    s_waitcnt vmcnt(1)
    v_xor_b32 v96, s76, v96
    v_xor_b32 v97, s77, v97
    v_xor_b32 v98, s78, v98
    v_xor_b32 v99, s79, v99
    v_or3_b32 v16, v16, v96, v97
    v_or3_b32 v16, v16, v98, v99
    s_waitcnt vmcnt(0)
    v_xor_b32 v100, s76, v100
    v_xor_b32 v101, s77, v101
    v_xor_b32 v102, s78, v102
    v_xor_b32 v103, s79, v103
    v_or3_b32 v16, v16, v100, v101
    v_or3_b32 v16, v16, v102, v103
    v_and_b32 v16, 0xff, v16
    v_cmp_ne_u32 vcc, 0, v16
    s_cbranch_vccnz L_gc_67
L_gd_66:
    v_pk_add_f32 v[72:73], v[72:73], v[76:77]
    v_pk_add_f32 v[74:75], v[74:75], v[78:79]
    s_nop 0
    v_permlane32_swap_b32 v72, v73
    v_permlane32_swap_b32 v74, v75
    v_add_f32 v72, v72, v73
    v_add_f32 v74, v74, v75
    s_nop 1
    v_permlane16_swap_b32 v72, v74
    v_add_f32 v72, v72, v74
    s_nop 1
    v_add_f32_dpp v72, v72, v72 row_ror:8 row_mask:0xf bank_mask:0xf
    v_cvt_pk_bf16_f32 v72, 0, v72
    v_pk_add_f32 v[80:81], v[80:81], v[84:85]
    v_pk_add_f32 v[82:83], v[82:83], v[86:87]
    s_nop 0
    v_permlane32_swap_b32 v80, v81
    v_permlane32_swap_b32 v82, v83
    v_add_f32 v80, v80, v81
    v_add_f32 v82, v82, v83
    s_nop 1
    v_permlane16_swap_b32 v80, v82
    v_add_f32 v80, v80, v82
    s_nop 1
    v_add_f32_dpp v80, v80, v80 row_ror:8 row_mask:0xf bank_mask:0xf
    v_cvt_pk_bf16_f32 v80, 0, v80
    v_pk_add_f32 v[88:89], v[88:89], v[92:93]
    v_pk_add_f32 v[90:91], v[90:91], v[94:95]
    s_nop 0
    v_permlane32_swap_b32 v88, v89
    v_permlane32_swap_b32 v90, v91
    v_add_f32 v88, v88, v89
    v_add_f32 v90, v90, v91
    s_nop 1
    v_permlane16_swap_b32 v88, v90
    v_add_f32 v88, v88, v90
    s_nop 1
    v_add_f32_dpp v88, v88, v88 row_ror:8 row_mask:0xf bank_mask:0xf
    v_cvt_pk_bf16_f32 v88, 0, v88
    v_pk_add_f32 v[96:97], v[96:97], v[100:101]
    v_pk_add_f32 v[98:99], v[98:99], v[102:103]
    s_nop 0
    v_permlane32_swap_b32 v96, v97
    v_permlane32_swap_b32 v98, v99
    v_add_f32 v96, v96, v97
    v_add_f32 v98, v98, v99
    s_nop 1
    v_permlane16_swap_b32 v96, v98
    v_add_f32 v96, v96, v98
    s_nop 1
    v_add_f32_dpp v96, v96, v96 row_ror:8 row_mask:0xf bank_mask:0xf
    v_cvt_pk_bf16_f32 v96, 0, v96
    v_and_or_b32 v104, v72, v23, s76
    v_and_or_b32 v105, v80, v23, s77
    v_and_or_b32 v106, v88, v23, s78
    v_and_or_b32 v107, v96, v23, s79
    v_lshlrev_b32 v16, 3, v13
    s_lshl_b32 s5, s36, 11
    s_lshl_b32 s6, s37, 9
    s_add_u32 s5, s5, s6
    s_add_u32 s5, s5, 6291456
    s_mov_b32 exec_lo, 0xff00ff
    s_mov_b32 exec_hi, 0xff00ff
    buffer_store_dwordx4 v[104:107], v16, s[8:11], s5 offen sc1
    s_mov_b64 exec, -1
L_modf_done:
    s_cmp_lg_u32 s28, 0
    s_cbranch_scc1 L_ml_done
    v_lshl_add_u32 v7, v1, 3, s80
L_lw_68:
    ds_read_b32 v16, v2 offset:60
    s_waitcnt lgkmcnt(0)
    v_readfirstlane_b32 s5, v16
    s_nop 0
    s_cmp_ge_u32 s5, 8
    s_cbranch_scc1 L_lwd_69
    s_sleep 1
    s_sub_u32 s4, s4, 1
    s_cbranch_scc1 L_end
    s_branch L_lw_68
L_lwd_69:
    s_nop 0
    buffer_load_dwordx2 v[104:105], v7, s[8:11], 0 offen sc1
    s_mov_b32 s5, 512
    buffer_load_dwordx2 v[106:107], v7, s[8:11], s5 offen sc1
    s_mov_b32 s5, 1024
    buffer_load_dwordx2 v[108:109], v7, s[8:11], s5 offen sc1
    s_mov_b32 s5, 1536
    buffer_load_dwordx2 v[110:111], v7, s[8:11], s5 offen sc1
    s_mov_b32 s5, 2048
    buffer_load_dwordx2 v[112:113], v7, s[8:11], s5 offen sc1
    s_mov_b32 s5, 2560
    buffer_load_dwordx2 v[114:115], v7, s[8:11], s5 offen sc1
    s_mov_b32 s5, 3072
    buffer_load_dwordx2 v[116:117], v7, s[8:11], s5 offen sc1
    s_mov_b32 s5, 3584
    buffer_load_dwordx2 v[118:119], v7, s[8:11], s5 offen sc1
    s_waitcnt vmcnt(7)
    v_max_u32 v16, v104, v105
    s_waitcnt vmcnt(6)
    v_max3_u32 v16, v16, v106, v107
    s_waitcnt vmcnt(5)
    v_max3_u32 v16, v16, v108, v109
    s_waitcnt vmcnt(4)
    v_max3_u32 v16, v16, v110, v111
    s_waitcnt vmcnt(3)
    v_max3_u32 v16, v16, v112, v113
    s_waitcnt vmcnt(2)
    v_max3_u32 v16, v16, v114, v115
    s_waitcnt vmcnt(1)
    v_max3_u32 v16, v16, v116, v117
    s_waitcnt vmcnt(0)
    v_max3_u32 v16, v16, v118, v119
    v_cmp_eq_u32 vcc, -1, v16
    s_cbranch_vccnz L_gc_72
L_gd_71:
    v_max3_f32 v120, v104, v106, v108
    v_max3_f32 v120, v120, v110, v112
    v_max3_f32 v120, v120, v114, v116
    v_max_f32 v120, v120, v118
    s_nop 1
    v_max_f32_dpp v120, v120, v120 row_ror:8 row_mask:0xf bank_mask:0xf
    v_mov_b32 v122, v120
    s_nop 1
    v_permlane16_swap_b32 v120, v122
    v_max_f32 v120, v120, v122
    v_mov_b32 v122, v120
    s_nop 1
    v_permlane32_swap_b32 v120, v122
    v_max_f32 v120, v120, v122
    v_sub_f32 v104, v104, v120
    v_mul_f32 v104, s33, v104
    v_exp_f32 v104, v104
    v_sub_f32 v106, v106, v120
    v_mul_f32 v106, s33, v106
    v_exp_f32 v106, v106
    v_sub_f32 v108, v108, v120
    v_mul_f32 v108, s33, v108
    v_exp_f32 v108, v108
    v_sub_f32 v110, v110, v120
    v_mul_f32 v110, s33, v110
    v_exp_f32 v110, v110
    v_sub_f32 v112, v112, v120
    v_mul_f32 v112, s33, v112
    v_exp_f32 v112, v112
    v_sub_f32 v114, v114, v120
    v_mul_f32 v114, s33, v114
    v_exp_f32 v114, v114
    v_sub_f32 v116, v116, v120
    v_mul_f32 v116, s33, v116
    v_exp_f32 v116, v116
    v_sub_f32 v118, v118, v120
    v_mul_f32 v118, s33, v118
    v_exp_f32 v118, v118
    v_mul_f32 v104, v104, v105
    v_mul_f32 v106, v106, v107
    v_mul_f32 v108, v108, v109
    v_mul_f32 v110, v110, v111
    v_mul_f32 v112, v112, v113
    v_mul_f32 v114, v114, v115
    v_mul_f32 v116, v116, v117
    v_mul_f32 v118, v118, v119
    v_add_f32 v104, v104, v106
    v_add_f32 v108, v108, v110
    v_add_f32 v112, v112, v114
    v_add_f32 v116, v116, v118
    v_add_f32 v104, v104, v108
    v_add_f32 v112, v112, v116
    v_add_f32 v104, v104, v112
    s_nop 1
    v_add_f32_dpp v104, v104, v104 row_ror:8 row_mask:0xf bank_mask:0xf
    v_mov_b32 v122, v104
    s_nop 1
    v_permlane16_swap_b32 v104, v122
    v_add_f32 v104, v104, v122
    v_mov_b32 v122, v104
    s_nop 1
    v_permlane32_swap_b32 v104, v122
    v_add_f32 v104, v104, v122
    v_rcp_f32 v121, v104
    v_lshlrev_b32 v122, 3, v1
    v_add_u32 v122, 151552, v122
    s_mov_b64 exec, 0xff
    ds_write_b64 v122, v[120:121]
    s_waitcnt lgkmcnt(0)
    s_mov_b64 exec, 1
    ds_add_u32 v2, v3 offset:44
    s_mov_b64 exec, -1
L_ml_done:
    s_cmp_lg_u32 s28, 3
    s_cbranch_scc1 L_bale_74
    s_mul_i32 s36, s30, 10112
    s_add_u32 s36, s36, 1280
    s_lshr_b32 s37, s2, 3
    s_lshl_b32 s37, s37, 2
    s_add_u32 s37, s37, s36
    v_lshlrev_b32 v40, 2, v1
    v_lshlrev_b32 v41, 10, v14
L_bal_73:
    ds_read_b32 v42, v2 offset:80
    s_waitcnt lgkmcnt(0)
    v_readfirstlane_b32 s41, v42
    s_nop 0
    s_sub_u32 s41, s41, s39
    v_or_b32 v42, s41, v41
    s_mov_b64 exec, 1
    buffer_store_dword v42, off, s[8:11], s37
    s_mov_b64 exec, -1
    s_cmp_ge_u32 s41, 200
    s_cbranch_scc1 L_bale_74
    s_mov_b32 exec_hi, 0
    buffer_load_dword v43, v40, s[8:11], s36 offen sc1
    s_mov_b64 exec, -1
    s_sub_u32 s4, s4, 1
    s_cbranch_scc1 L_end
    s_waitcnt vmcnt(0)
    v_xor_b32 v43, v43, v41
    v_cmp_gt_u32 vcc, 1024, v43
    s_nop 1
    v_cndmask_b32 v43, 0, v43, vcc
    s_nop 1
    v_add_u32_dpp v43, v43, v43 row_ror:1 row_mask:0xf bank_mask:0xf
    s_nop 1
    v_add_u32_dpp v43, v43, v43 row_ror:2 row_mask:0xf bank_mask:0xf
    s_nop 1
    v_add_u32_dpp v43, v43, v43 row_ror:4 row_mask:0xf bank_mask:0xf
    s_nop 1
    v_add_u32_dpp v43, v43, v43 row_ror:8 row_mask:0xf bank_mask:0xf
    v_mov_b32 v44, v43
    s_nop 1
    v_permlane16_swap_b32 v43, v44
    v_add_u32 v43, v43, v44
    s_nop 0
    v_readfirstlane_b32 s42, v43
    s_nop 0
    s_lshr_b32 s42, s42, 5
    s_sub_u32 s42, s42, s41
    s_sub_u32 s43, s42, s39
    s_mov_b32 s39, s42
    v_mov_b32 v42, s43
    s_mov_b64 exec, 1
    ds_add_u32 v2, v42 offset:80
    s_mov_b64 exec, -1
    s_branch L_bal_73
L_bale_74:
L_lw_75:
    ds_read_b32 v16, v2 offset:60
    s_waitcnt lgkmcnt(0)
    v_readfirstlane_b32 s5, v16
    s_nop 0
    s_cmp_ge_u32 s5, 8
    s_cbranch_scc1 L_lwd_76
    s_sleep 4
    s_sub_u32 s4, s4, 1
    s_cbranch_scc1 L_end
    s_branch L_lw_75
L_lwd_76:
L_lw_77:
    ds_read_b32 v16, v2 offset:72
    s_waitcnt lgkmcnt(0)
    v_readfirstlane_b32 s5, v16
    s_nop 0
    s_cmp_ge_u32 s5, 1
    s_cbranch_scc1 L_lwd_78
    s_sleep 2
    s_sub_u32 s4, s4, 1
    s_cbranch_scc1 L_end
    s_branch L_lw_77
L_lwd_78:
    s_sub_u32 s31, s5, 1
    s_and_b32 s12, s31, 7
    s_mul_i32 s13, s31, 10112
    s_lshl_b32 s32, s12, 7
    s_lshl_b32 s5, s28, 5
    s_add_u32 s32, s32, s5
    s_lshl_b32 s5, s32, 1
    buffer_load_ushort v9, v13, s[16:19], s5 offen
    v_lshrrev_b32 v16, 3, v1
    v_mul_u32_u24 v17, 10112, v16
    v_and_b32 v18, 7, v1
    v_lshlrev_b32 v18, 4, v18
    s_mul_i32 s34, s12, 10112
    s_lshl_b32 s6, s28, 7
    s_add_u32 s34, s34, s6
    s_lshl_b32 s5, s32, 4
    v_lshl_add_u32 v7, v13, 3, s5
    s_nop 0
    s_mov_b32 s5, 6291456
    buffer_load_dwordx4 v[72:75], v7, s[8:11], s5 offen sc1
    s_waitcnt vmcnt(0)
    v_xor_b32 v72, s76, v72
    v_xor_b32 v73, s77, v73
    v_xor_b32 v74, s78, v74
    v_xor_b32 v75, s79, v75
    v_or3_b32 v16, v72, v73, v74
    v_or_b32 v16, v16, v75
    v_and_b32 v16, 0xff, v16
    v_cmp_ne_u32 vcc, 0, v16
    s_cbranch_vccnz L_gc_81
L_gd_80:
    v_and_b32 v19, 8, v1
    v_mul_u32_u24 v19, 40, v19
    s_lshl_b32 s5, s28, 6
    s_add_u32 s5, s5, 151808
    v_add3_u32 v22, v19, v13, s5
    v_mov_b32 v15, v13
    v_mov_b32 v10, v72
    v_mov_b32 v11, v75
    v_add_f32 v13, 1.0, v74
    v_cvt_pk_bf16_f32 v13, 0, v13
    s_nop 1
    v_mov_b32_dpp v73, v13 quad_perm:[0,1,2,3] row_mask:0xf bank_mask:0x3
    ds_write_b16_d16_hi v22, v73 offset:640
    v_lshlrev_b32 v9, 16, v9
    s_lshr_b32 s5, s2, 6
    s_mul_i32 s5, s5, 10112
    s_lshl_b32 s6, s30, 9
    s_add_u32 s5, s5, s6
    s_lshl_b32 s7, s28, 7
    s_add_u32 s5, s5, s7
    v_lshl_add_u32 v21, v17, 2, v18
    v_add_u32 v21, s5, v21
    s_mul_i32 s5, s12, 80896
    s_add_u32 s5, s5, s7
    v_add3_u32 v7, v17, v18, s5
    v_lshl_add_u32 v17, v17, 3, v18
    v_add_u32 v17, s34, v17
    s_and_b32 s5, s31, 0xf8
    s_mul_i32 s5, s5, 10112
    s_lshl_b32 s6, s28, 8
    s_add_u32 s5, s5, s6
    v_lshrrev_b32 v16, 4, v1
    v_mul_u32_u24 v16, 10112, v16
    v_and_b32 v18, 15, v1
    v_lshlrev_b32 v18, 4, v18
    v_add3_u32 v18, v16, v18, s5
    v_lshrrev_b32 v16, 4, v1
    v_and_b32 v19, 15, v1
    v_lshlrev_b32 v32, 10, v16
    v_lshl_add_u32 v32, v19, 4, v32
    s_lshl_b32 s5, s28, 8
    s_add_u32 s5, s5, 32768
    v_add_u32 v32, s5, v32
    v_and_b32 v33, 7, v1
    v_lshlrev_b32 v33, 9, v33
    v_lshl_add_u32 v33, v16, 4, v33
    v_and_b32 v19, 8, v1
    v_lshl_add_u32 v33, v19, 3, v33
    s_lshl_b32 s37, s28, 7
    s_add_u32 s37, s37, s29
    s_add_u32 s37, s37, 4096
    v_and_b32 v19, 7, v1
    v_bfe_u32 v20, v1, 4, 1
    v_lshl_add_u32 v19, v20, 4, v19
    v_lshrrev_b32 v20, 5, v1
    v_lshl_add_u32 v19, v20, 3, v19
    s_lshl_b32 s5, s28, 6
    s_add_u32 s5, s5, 150272
    v_lshl_add_u32 v34, v19, 1, s5
    v_lshlrev_b32 v0, 2, v1
    v_add_u32 v0, 147456, v0
    v_readfirstlane_b32 s35, v14
    s_nop 0
    s_lshl_b32 s35, s35, 10
    s_or_b32 s35, s35, 233
    s_lshl_b32 s5, s28, 7
    s_add_u32 s5, s5, s13
    s_add_u32 s5, s5, 3584
    s_mov_b64 exec, 1
    buffer_load_dword v14, off, s[8:11], s5 sc1
    s_mov_b64 exec, -1
    s_lshl_b32 s5, s28, 7
    s_add_u32 s5, s5, s29
    s_add_u32 s5, s5, 3072
    s_mov_b64 exec, 1
    buffer_load_dword v14, off, s[8:11], s5 sc1
    s_mov_b64 exec, -1
    s_cmp_lg_u32 s28, 3
    s_cbranch_scc1 L_cm_done
L_lw_82:
    ds_read_b32 v16, v2 offset:100
    s_waitcnt lgkmcnt(0)
    v_readfirstlane_b32 s5, v16
    s_nop 0
    s_cmp_ge_u32 s5, 8
    s_cbranch_scc1 L_lwd_83
    s_sleep 1
    s_sub_u32 s4, s4, 1
    s_cbranch_scc1 L_end
    s_branch L_lw_82
L_lwd_83:
    s_mul_i32 s36, s30, 10112
    s_add_u32 s36, s36, 1280
    s_lshr_b32 s5, s2, 3
    s_lshl_b32 s5, s5, 2
    s_add_u32 s5, s5, s36
    v_lshlrev_b32 v72, 2, v1
    v_mov_b32 v73, s35
    v_mov_b32 v76, 8
    s_mov_b64 exec, 1
    buffer_store_dword v73, off, s[8:11], s5
    s_mov_b32 exec_lo, -1
    buffer_load_dword v74, v72, s[8:11], s36 offen sc1
    s_mov_b64 exec, -1
L_cm_done:
    s_waitcnt lgkmcnt(0)
    s_barrier
    ds_read_b128 v[136:139], v32 offset:0
    ds_read_b128 v[140:143], v32 offset:4096
    ds_read_b128 v[144:147], v32 offset:8192
    ds_read_b128 v[148:151], v32 offset:12288
    ds_read_b128 v[152:155], v32 offset:16384
    ds_read_b128 v[156:159], v32 offset:20480
    ds_read_b128 v[160:163], v32 offset:24576
    ds_read_b128 v[164:167], v32 offset:28672
    s_waitcnt lgkmcnt(4)
    v_pk_add_f32 v[136:137], v[136:137], v[140:141]
    v_pk_add_f32 v[138:139], v[138:139], v[142:143]
    v_pk_add_f32 v[144:145], v[144:145], v[148:149]
    v_pk_add_f32 v[146:147], v[146:147], v[150:151]
    v_pk_add_f32 v[136:137], v[136:137], v[144:145]
    v_pk_add_f32 v[138:139], v[138:139], v[146:147]
    s_waitcnt lgkmcnt(0)
    v_pk_add_f32 v[152:153], v[152:153], v[156:157]
    v_pk_add_f32 v[154:155], v[154:155], v[158:159]
    v_pk_add_f32 v[160:161], v[160:161], v[164:165]
    v_pk_add_f32 v[162:163], v[162:163], v[166:167]
    v_pk_add_f32 v[152:153], v[152:153], v[160:161]
    v_pk_add_f32 v[154:155], v[154:155], v[162:163]
    v_pk_add_f32 v[136:137], v[136:137], v[152:153]
    v_pk_add_f32 v[138:139], v[138:139], v[154:155]
    v_and_or_b32 v136, v136, v23, s76
    v_and_or_b32 v137, v137, v23, s77
    v_and_or_b32 v138, v138, v23, s78
    v_and_or_b32 v139, v139, v23, s79
    buffer_store_dwordx4 v[136:139], v33, s[8:11], s37 offen sc1
    s_mov_b64 exec, 1
    ds_add_u32 v2, v3 offset:68
    s_mov_b64 exec, -1
    s_cmp_lg_u32 s28, 3
    s_cbranch_scc1 L_cd_done
    s_mov_b32 exec_hi, 0
    s_waitcnt vmcnt(1)
    s_branch L_cd_chk
L_cd:
    buffer_load_dword v74, v72, s[8:11], s36 offen sc1
    ds_read_b32 v75, v2 offset:88
    s_sub_u32 s4, s4, 1
    s_cbranch_scc1 L_end
    s_waitcnt lgkmcnt(0)
    v_readfirstlane_b32 s5, v75
    s_nop 0
    s_cmp_ge_u32 s5, 8
    s_cbranch_scc1 L_cd_out
    s_waitcnt vmcnt(0)
L_cd_chk:
    v_cmp_eq_u32 vcc, s35, v74
    s_nop 0
    s_bcnt1_i32_b64 s5, vcc
    s_cmp_lt_u32 s5, 32
    s_cbranch_scc1 L_cd
    s_mov_b64 exec, 1
    ds_add_u32 v2, v76 offset:88
L_cd_out:
    s_mov_b64 exec, -1
L_cd_done:
L_lw_84:
    ds_read_b32 v16, v2 offset:96
    s_waitcnt lgkmcnt(0)
    v_readfirstlane_b32 s5, v16
    s_nop 0
    s_cmp_ge_u32 s5, 8
    s_cbranch_scc1 L_lwd_85
    s_sleep 1
    s_sub_u32 s4, s4, 1
    s_cbranch_scc1 L_end
    s_branch L_lw_84
L_lwd_85:
L_lw_86:
    ds_read_b32 v16, v2 offset:88
    s_waitcnt lgkmcnt(0)
    v_readfirstlane_b32 s5, v16
    s_nop 0
    s_cmp_ge_u32 s5, 8
    s_cbranch_scc1 L_lwd_87
    s_sleep 1
    s_sub_u32 s4, s4, 1
    s_cbranch_scc1 L_end
    s_branch L_lw_86
L_lwd_87:
    s_nop 0
    s_mov_b32 s5, 4096
    buffer_load_dwordx4 v[104:107], v21, s[8:11], s5 offen sc1
    s_mov_b32 s5, 327680
    buffer_load_dwordx4 v[108:111], v21, s[8:11], s5 offen sc1
    s_mov_b32 s5, 651264
    buffer_load_dwordx4 v[112:115], v21, s[8:11], s5 offen sc1
    s_mov_b32 s5, 974848
    buffer_load_dwordx4 v[116:119], v21, s[8:11], s5 offen sc1
    s_mov_b32 s5, 1298432
    buffer_load_dwordx4 v[120:123], v21, s[8:11], s5 offen sc1
    s_mov_b32 s5, 1622016
    buffer_load_dwordx4 v[124:127], v21, s[8:11], s5 offen sc1
    s_mov_b32 s5, 1945600
    buffer_load_dwordx4 v[128:131], v21, s[8:11], s5 offen sc1
    s_mov_b32 s5, 2269184
    buffer_load_dwordx4 v[132:135], v21, s[8:11], s5 offen sc1
L_lw_91:
    ds_read_b32 v19, v2 offset:16
    s_waitcnt lgkmcnt(0)
    v_readfirstlane_b32 s5, v19
    s_nop 0
    s_cmp_ge_u32 s5, 8
    s_cbranch_scc1 L_lwd_92
    s_sub_u32 s4, s4, 1
    s_cbranch_scc1 L_end
    s_branch L_lw_91
L_lwd_92:
    v_add_u32 v19, 81920, v4
    v_xor_b32 v20, 32, v19
    ds_read_b64_tr_b16 v[40:41], v19 offset:0
    ds_read_b64_tr_b16 v[42:43], v19 offset:1024
    ds_read_b64_tr_b16 v[44:45], v19 offset:8192
    ds_read_b64_tr_b16 v[46:47], v19 offset:9216
    ds_read_b64_tr_b16 v[48:49], v19 offset:16384
    ds_read_b64_tr_b16 v[50:51], v19 offset:17408
    ds_read_b64_tr_b16 v[52:53], v19 offset:24576
    ds_read_b64_tr_b16 v[54:55], v19 offset:25600
    ds_read_b64_tr_b16 v[56:57], v20 offset:0
    ds_read_b64_tr_b16 v[58:59], v20 offset:1024
    ds_read_b64_tr_b16 v[60:61], v20 offset:8192
    ds_read_b64_tr_b16 v[62:63], v20 offset:9216
    ds_read_b64_tr_b16 v[64:65], v20 offset:16384
    ds_read_b64_tr_b16 v[66:67], v20 offset:17408
    ds_read_b64_tr_b16 v[68:69], v20 offset:24576
    ds_read_b64_tr_b16 v[70:71], v20 offset:25600
    s_waitcnt vmcnt(7)
    v_xor_b32 v104, s76, v104
    v_xor_b32 v105, s77, v105
    v_xor_b32 v106, s78, v106
    v_xor_b32 v107, s79, v107
    v_or3_b32 v16, v104, v105, v106
    v_or_b32 v16, v16, v107
    s_waitcnt vmcnt(6)
    v_xor_b32 v108, s76, v108
    v_xor_b32 v109, s77, v109
    v_xor_b32 v110, s78, v110
    v_xor_b32 v111, s79, v111
    v_or3_b32 v16, v16, v108, v109
    v_or3_b32 v16, v16, v110, v111
    v_pk_add_f32 v[142:143], v[106:107], v[110:111]
    v_pk_add_f32 v[140:141], v[104:105], v[108:109]
    s_waitcnt vmcnt(5)
    v_xor_b32 v112, s76, v112
    v_xor_b32 v113, s77, v113
    v_xor_b32 v114, s78, v114
    v_xor_b32 v115, s79, v115
    v_or3_b32 v16, v16, v112, v113
    v_or3_b32 v16, v16, v114, v115
    v_pk_add_f32 v[142:143], v[142:143], v[114:115]
    v_pk_add_f32 v[140:141], v[140:141], v[112:113]
    s_waitcnt vmcnt(4)
    v_xor_b32 v116, s76, v116
    v_xor_b32 v117, s77, v117
    v_xor_b32 v118, s78, v118
    v_xor_b32 v119, s79, v119
    v_or3_b32 v16, v16, v116, v117
    v_or3_b32 v16, v16, v118, v119
    v_pk_add_f32 v[142:143], v[142:143], v[118:119]
    v_pk_add_f32 v[140:141], v[140:141], v[116:117]
    s_waitcnt vmcnt(3)
    v_xor_b32 v120, s76, v120
    v_xor_b32 v121, s77, v121
    v_xor_b32 v122, s78, v122
    v_xor_b32 v123, s79, v123
    v_or3_b32 v16, v16, v120, v121
    v_or3_b32 v16, v16, v122, v123
    v_pk_add_f32 v[142:143], v[142:143], v[122:123]
    v_pk_add_f32 v[140:141], v[140:141], v[120:121]
    s_waitcnt vmcnt(2)
    v_xor_b32 v124, s76, v124
    v_xor_b32 v125, s77, v125
    v_xor_b32 v126, s78, v126
    v_xor_b32 v127, s79, v127
    v_or3_b32 v16, v16, v124, v125
    v_or3_b32 v16, v16, v126, v127
    v_pk_add_f32 v[142:143], v[142:143], v[126:127]
    v_pk_add_f32 v[140:141], v[140:141], v[124:125]
    s_waitcnt vmcnt(1)
    v_xor_b32 v128, s76, v128
    v_xor_b32 v129, s77, v129
    v_xor_b32 v130, s78, v130
    v_xor_b32 v131, s79, v131
    v_or3_b32 v16, v16, v128, v129
    v_or3_b32 v16, v16, v130, v131
    v_pk_add_f32 v[142:143], v[142:143], v[130:131]
    v_pk_add_f32 v[140:141], v[140:141], v[128:129]
    s_waitcnt vmcnt(0)
    v_xor_b32 v132, s76, v132
    v_xor_b32 v133, s77, v133
    v_xor_b32 v134, s78, v134
    v_xor_b32 v135, s79, v135
    v_or3_b32 v16, v16, v132, v133
    v_or3_b32 v16, v16, v134, v135
    v_and_b32 v16, 0xff, v16
    v_cmp_ne_u32 vcc, 0, v16
    v_pk_add_f32 v[142:143], v[142:143], v[134:135]
    v_pk_add_f32 v[140:141], v[140:141], v[132:133]
    s_cbranch_vccnz L_gc_90
L_gd_89:
    s_nop 0
    v_permlane32_swap_b32 v140, v141
    v_permlane32_swap_b32 v142, v143
    v_add_f32 v140, v140, v141
    v_add_f32 v142, v142, v143
    s_nop 1
    v_permlane16_swap_b32 v140, v142
    v_add_f32 v140, v140, v142
    s_nop 1
    v_add_f32_dpp v140, v140, v140 row_ror:8 row_mask:0xf bank_mask:0xf
    v_cvt_pk_bf16_f32 v140, 0, v140
    ds_write_b16_d16_hi v34, v140
L_x_93:
    ds_read_b32 v16, v0 offset:2816
    ds_read_b128 v[24:27], v6 offset:2816
    ds_read_b128 v[28:31], v6 offset:2880
    ds_read_b128 v[32:35], v6 offset:2944
    ds_read_b128 v[36:39], v6 offset:3008
    s_waitcnt lgkmcnt(4)
    v_cmp_eq_u16 vcc, -1, v16
    v_cmp_le_u32 s[6:7], s38, v16
    s_nop 0
    s_or_b64 s[6:7], s[6:7], vcc
    s_cbranch_scc0 L_xd_94
    s_sub_u32 s4, s4, 1
    s_cbranch_scc1 L_end
    s_branch L_x_93
L_xd_94:
    s_waitcnt lgkmcnt(0)
    s_mul_i32 s5, s28, 128
    s_add_u32 s5, s5, s29
    s_add_u32 s5, s5, 3072
    v_mfma_f32_16x16x32_bf16 v[136:139], v[40:43], v[24:27], 0
    v_mfma_f32_16x16x32_bf16 v[136:139], v[44:47], v[28:31], v[136:139]
    v_mfma_f32_16x16x32_bf16 v[136:139], v[48:51], v[32:35], v[136:139]
    v_mfma_f32_16x16x32_bf16 v[136:139], v[52:55], v[36:39], v[136:139]
    v_mfma_f32_16x16x32_bf16 v[140:143], v[56:59], v[24:27], 0
    v_mfma_f32_16x16x32_bf16 v[140:143], v[60:63], v[28:31], v[140:143]
    v_mfma_f32_16x16x32_bf16 v[140:143], v[64:67], v[32:35], v[140:143]
    v_mfma_f32_16x16x32_bf16 v[140:143], v[68:71], v[36:39], v[140:143]
    s_mov_b32 exec_lo, 0x10001
    s_mov_b32 exec_hi, 0x10001
    s_nop 1
    v_and_or_b32 v152, v136, v23, s76
    v_and_or_b32 v153, v137, v23, s77
    v_and_or_b32 v154, v138, v23, s78
    v_and_or_b32 v155, v139, v23, s79
    s_mov_b32 exec_lo, 0x20002
    s_mov_b32 exec_hi, 0x20002
    v_and_or_b32 v152, v140, v23, s76
    v_and_or_b32 v153, v141, v23, s77
    v_and_or_b32 v154, v142, v23, s78
    v_and_or_b32 v155, v143, v23, s79
    s_mov_b32 exec_lo, 0x30003
    s_mov_b32 exec_hi, 0x30003
    buffer_store_dwordx4 v[152:155], v5, s[8:11], s5 offen sc1
    s_mov_b64 exec, -1
    s_mov_b64 exec, 1
    ds_add_u32 v2, v3 offset:64
    s_mov_b64 exec, -1
    s_cmp_lt_u32 s31, 224
    s_cbranch_scc1 L_ffn
    s_branch L_fin
L_ffn:
    s_mov_b32 s29, s13
    v_and_b32 v16, 3, v1
    v_mul_u32_u24 v19, 320, v16
    v_add_u32 v21, v19, v6
    v_bfe_u32 v19, v1, 2, 3
    v_mul_u32_u24 v19, 10112, v19
    v_lshl_add_u32 v70, v16, 4, v19
    s_and_b32 s5, s31, 0xf8
    s_mul_i32 s5, s5, 10112
    v_add_u32 v70, s5, v70
    s_lshl_b32 s36, s28, 8
    s_add_u32 s36, s36, s29
    s_add_u32 s36, s36, 8192
    v_lshlrev_b32 v71, 2, v1
    s_lshl_b32 s37, s28, 4
    s_add_u32 s37, s37, s29
    s_add_u32 s37, s37, 9216
    s_lshl_b32 s5, s28, 6
    s_add_u32 s5, s5, 150016
    v_add_u32 v8, s5, v15
    v_lshlrev_b32 v69, 7, v1
    s_lshl_b32 s5, s28, 8
    s_add_u32 s5, s5, s13
    s_add_u32 s5, s5, 8192
    s_mov_b64 exec, 7
    buffer_load_dword v69, v69, s[8:11], s5 offen sc1
    s_mov_b64 exec, -1
L_lw_95:
    ds_read_b32 v19, v2 offset:20
    s_waitcnt lgkmcnt(0)
    v_readfirstlane_b32 s5, v19
    s_nop 0
    s_cmp_ge_u32 s5, 8
    s_cbranch_scc1 L_lwd_96
    s_sub_u32 s4, s4, 1
    s_cbranch_scc1 L_end
    s_branch L_lw_95
L_lwd_96:
    v_add_u32 v19, 114688, v4
    v_xor_b32 v20, 32, v19
    ds_read_b64_tr_b16 v[72:73], v19 offset:0
    ds_read_b64_tr_b16 v[74:75], v19 offset:1024
    ds_read_b64_tr_b16 v[76:77], v19 offset:8192
    ds_read_b64_tr_b16 v[78:79], v19 offset:9216
    ds_read_b64_tr_b16 v[80:81], v19 offset:16384
    ds_read_b64_tr_b16 v[82:83], v19 offset:17408
    ds_read_b64_tr_b16 v[84:85], v19 offset:24576
    ds_read_b64_tr_b16 v[86:87], v19 offset:25600
    ds_read_b64_tr_b16 v[88:89], v20 offset:0
    ds_read_b64_tr_b16 v[90:91], v20 offset:1024
    ds_read_b64_tr_b16 v[92:93], v20 offset:8192
    ds_read_b64_tr_b16 v[94:95], v20 offset:9216
    ds_read_b64_tr_b16 v[96:97], v20 offset:16384
    ds_read_b64_tr_b16 v[98:99], v20 offset:17408
    ds_read_b64_tr_b16 v[100:101], v20 offset:24576
    ds_read_b64_tr_b16 v[102:103], v20 offset:25600
L_lw_97:
    ds_read_b32 v19, v2 offset:24
    s_waitcnt lgkmcnt(0)
    v_readfirstlane_b32 s5, v19
    s_nop 0
    s_cmp_ge_u32 s5, 8
    s_cbranch_scc1 L_lwd_98
    s_sub_u32 s4, s4, 1
    s_cbranch_scc1 L_end
    s_branch L_lw_97
L_lwd_98:
    v_add_u32 v19, 0, v4
    v_xor_b32 v20, 32, v19
    ds_read_b64_tr_b16 v[104:105], v19 offset:0
    ds_read_b64_tr_b16 v[106:107], v19 offset:1024
    ds_read_b64_tr_b16 v[108:109], v19 offset:8192
    ds_read_b64_tr_b16 v[110:111], v19 offset:9216
    ds_read_b64_tr_b16 v[112:113], v19 offset:16384
    ds_read_b64_tr_b16 v[114:115], v19 offset:17408
    ds_read_b64_tr_b16 v[116:117], v19 offset:24576
    ds_read_b64_tr_b16 v[118:119], v19 offset:25600
    ds_read_b64_tr_b16 v[120:121], v20 offset:0
    ds_read_b64_tr_b16 v[122:123], v20 offset:1024
    ds_read_b64_tr_b16 v[124:125], v20 offset:8192
    ds_read_b64_tr_b16 v[126:127], v20 offset:9216
    ds_read_b64_tr_b16 v[128:129], v20 offset:16384
    ds_read_b64_tr_b16 v[130:131], v20 offset:17408
    ds_read_b64_tr_b16 v[132:133], v20 offset:24576
    ds_read_b64_tr_b16 v[134:135], v20 offset:25600
L_lw_99:
    ds_read_b32 v16, v2 offset:92
    s_waitcnt lgkmcnt(0)
    v_readfirstlane_b32 s5, v16
    s_nop 0
    s_cmp_ge_u32 s5, 8
    s_cbranch_scc1 L_lwd_100
    s_sleep 1
    s_sub_u32 s4, s4, 1
    s_cbranch_scc1 L_end
    s_branch L_lw_99
L_lwd_100:
    s_waitcnt vmcnt(0)
    s_nop 0
    s_mov_b32 s5, 3072
    buffer_load_dwordx4 v[40:43], v7, s[8:11], s5 offen sc1
    s_mov_b32 s5, 650240
    buffer_load_dwordx4 v[44:47], v7, s[8:11], s5 offen sc1
    s_mov_b32 s5, 1297408
    buffer_load_dwordx4 v[48:51], v7, s[8:11], s5 offen sc1
    s_mov_b32 s5, 1944576
    buffer_load_dwordx4 v[52:55], v7, s[8:11], s5 offen sc1
    s_waitcnt vmcnt(3)
    v_xor_b32 v40, s76, v40
    v_xor_b32 v41, s77, v41
    v_xor_b32 v42, s78, v42
    v_xor_b32 v43, s79, v43
    v_or3_b32 v16, v40, v41, v42
    v_or_b32 v16, v16, v43
    s_waitcnt vmcnt(2)
    v_xor_b32 v44, s76, v44
    v_xor_b32 v45, s77, v45
    v_xor_b32 v46, s78, v46
    v_xor_b32 v47, s79, v47
    v_or3_b32 v16, v16, v44, v45
    v_or3_b32 v16, v16, v46, v47
    v_pk_add_f32 v[66:67], v[42:43], v[46:47]
    v_pk_add_f32 v[64:65], v[40:41], v[44:45]
    s_waitcnt vmcnt(1)
    v_xor_b32 v48, s76, v48
    v_xor_b32 v49, s77, v49
    v_xor_b32 v50, s78, v50
    v_xor_b32 v51, s79, v51
    v_or3_b32 v16, v16, v48, v49
    v_or3_b32 v16, v16, v50, v51
    v_pk_add_f32 v[66:67], v[66:67], v[50:51]
    v_pk_add_f32 v[64:65], v[64:65], v[48:49]
    s_waitcnt vmcnt(0)
    v_xor_b32 v52, s76, v52
    v_xor_b32 v53, s77, v53
    v_xor_b32 v54, s78, v54
    v_xor_b32 v55, s79, v55
    v_or3_b32 v16, v16, v52, v53
    v_or3_b32 v16, v16, v54, v55
    v_and_b32 v16, 0xff, v16
    v_cmp_ne_u32 vcc, 0, v16
    v_pk_add_f32 v[66:67], v[66:67], v[54:55]
    v_pk_add_f32 v[64:65], v[64:65], v[52:53]
    s_cbranch_vccnz L_gc_103
L_gd_102:
    s_nop 0
    v_permlane32_swap_b32 v64, v65
    v_permlane32_swap_b32 v66, v67
    v_add_f32 v64, v64, v65
    v_add_f32 v66, v66, v67
    s_nop 1
    v_permlane16_swap_b32 v64, v66
    v_add_f32 v64, v64, v66
    s_nop 1
    v_add_f32_dpp v64, v64, v64 row_ror:8 row_mask:0xf bank_mask:0xf
    v_cvt_pk_bf16_f32 v64, 0, v64
    v_mul_f32 v64, v64, v10
    v_cvt_pk_bf16_f32 v64, 0, v64
    v_add_f32 v9, v9, v64
    v_cvt_pk_bf16_f32 v9, 0, v9
    v_mov_b32 v68, v9
    v_mul_f32 v64, v9, v13
    s_nop 0
    v_mul_f32_dpp v68, v9, v9 quad_perm:[0,1,2,3] row_mask:0xf bank_mask:0xc
    v_mov_b32 v69, v68
    v_cvt_pk_bf16_f32 v65, 0, v64
    s_nop 0
    v_permlane32_swap_b32 v68, v69
    v_add_f32 v68, v68, v69
    v_mov_b32 v69, v68
    v_subrev_f32_dpp v64, v65, v64 quad_perm:[0,1,2,3] row_mask:0xf bank_mask:0xc
    v_cvt_pk_bf16_f32 v64, 0, v64
    v_permlane16_swap_b32 v68, v69
    v_add_f32 v68, v68, v69
    ds_write_b16_d16_hi v22, v64
    s_nop 0
    v_add_f32_dpp v68, v68, v68 quad_perm:[1,0,3,2] row_mask:0xf bank_mask:0xf
    s_nop 1
    v_add_f32_dpp v68, v68, v68 quad_perm:[2,3,0,1] row_mask:0xf bank_mask:0xf
    s_nop 1
    v_add_f32_dpp v68, v68, v68 row_half_mirror row_mask:0xf bank_mask:0xf
    v_and_b32 v40, v68, v23
    v_sub_f32 v41, v68, v40
    v_and_or_b32 v40, v40, v23, s76
    v_mov_b32_dpp v42, v68 row_ror:8 row_mask:0xf bank_mask:0xf
    v_mov_b32_dpp v43, v41 row_ror:8 row_mask:0xf bank_mask:0xf
    v_and_or_b32 v41, v41, v23, s77
    v_and_or_b32 v42, v42, v23, s78
    v_and_or_b32 v43, v43, v23, s79
    s_mov_b64 exec, 1
    s_cmp_eq_u32 s15, 0
    s_cbranch_scc1 L_far_104
    buffer_store_dwordx4 v[40:43], off, s[8:11], s37
L_stj_105:
    s_mov_b64 exec, -1
    s_mov_b32 s34, 9216
L_x_106:
    ds_read_b32 v19, v0 offset:4352
    ds_read_b32 v20, v0 offset:4672
    ds_read_b128 v[24:27], v21 offset:4352
    ds_read_b128 v[28:31], v21 offset:4416
    ds_read_b128 v[32:35], v21 offset:4480
    ds_read_b128 v[36:39], v21 offset:4544
    s_waitcnt lgkmcnt(4)
    v_pk_max_u16 v19, v19, v20
    v_cmp_eq_u16 vcc, -1, v19
    v_cmp_le_u32 s[6:7], s38, v19
    s_nop 0
    s_or_b64 s[6:7], s[6:7], vcc
    s_cbranch_scc0 L_xd_107
    s_sub_u32 s4, s4, 1
    s_cbranch_scc1 L_end
    s_branch L_x_106
L_xd_107:
    s_waitcnt lgkmcnt(0)
    v_mfma_f32_16x16x32_bf16 v[40:43], v[24:27], v[72:75], 0
    v_mfma_f32_16x16x32_bf16 v[40:43], v[28:31], v[76:79], v[40:43]
    v_mfma_f32_16x16x32_bf16 v[40:43], v[32:35], v[80:83], v[40:43]
    v_mfma_f32_16x16x32_bf16 v[40:43], v[36:39], v[84:87], v[40:43]
    v_mov_b32 v60, s76
    v_mov_b32 v61, s77
    v_mov_b32 v62, s78
    v_mov_b32 v63, s79
    v_mfma_f32_16x16x32_bf16 v[44:47], v[24:27], v[88:91], 0
    v_mfma_f32_16x16x32_bf16 v[44:47], v[28:31], v[92:95], v[44:47]
    v_mfma_f32_16x16x32_bf16 v[44:47], v[32:35], v[96:99], v[44:47]
    v_mfma_f32_16x16x32_bf16 v[44:47], v[36:39], v[100:103], v[44:47]
    s_mov_b32 exec_lo, 0xffff
    s_mov_b32 exec_hi, 0x0
    v_add_f32 v56, v40, v41
    v_pk_mov_b32 v[58:59], v[42:43], v[42:43] op_sel:[0,1]
    s_mov_b64 exec, -1
    buffer_load_dwordx4 v[64:67], v70, s[8:11], s34 offen sc1
    v_mfma_f32_16x16x32_bf16 v[48:51], v[24:27], v[104:107], 0
    v_mfma_f32_16x16x32_bf16 v[48:51], v[28:31], v[108:111], v[48:51]
    v_mfma_f32_16x16x32_bf16 v[48:51], v[32:35], v[112:115], v[48:51]
    v_mfma_f32_16x16x32_bf16 v[48:51], v[36:39], v[116:119], v[48:51]
    s_mov_b32 exec_lo, 0xffff0000
    s_mov_b32 exec_hi, 0x0
    v_add_f32 v56, v44, v45
    v_pk_mov_b32 v[58:59], v[46:47], v[46:47] op_sel:[0,1]
    s_mov_b64 exec, -1
    v_mfma_f32_16x16x32_bf16 v[52:55], v[24:27], v[120:123], 0
    v_mfma_f32_16x16x32_bf16 v[52:55], v[28:31], v[124:127], v[52:55]
    v_mfma_f32_16x16x32_bf16 v[52:55], v[32:35], v[128:131], v[52:55]
    v_mfma_f32_16x16x32_bf16 v[52:55], v[36:39], v[132:135], v[52:55]
    s_mov_b32 exec_lo, 0x0
    s_mov_b32 exec_hi, 0xffff
    v_add_f32 v56, v48, v49
    v_pk_mov_b32 v[58:59], v[50:51], v[50:51] op_sel:[0,1]
    s_mov_b32 exec_lo, 0x0
    s_mov_b32 exec_hi, 0xffff0000
    s_nop 1
    v_add_f32 v56, v52, v53
    v_pk_mov_b32 v[58:59], v[54:55], v[54:55] op_sel:[0,1]
    s_mov_b64 exec, -1
    s_branch L_mchk
L_mld:
    buffer_load_dwordx4 v[64:67], v70, s[8:11], s34 offen sc1
    s_sub_u32 s4, s4, 1
    s_cbranch_scc1 L_end
L_mchk:
    s_waitcnt vmcnt(0)
    v_xor_b32 v64, s76, v64
    v_xor_b32 v65, s77, v65
    v_xor_b32 v66, s78, v66
    v_xor_b32 v67, s79, v67
    v_or3_b32 v16, v64, v65, v66
    v_or_b32 v16, v16, v67
    v_and_b32 v16, 0xff, v16
    v_cmp_ne_u32 vcc, 0, v16
    s_cbranch_vccnz L_mld
    v_add_f32 v64, v64, v65
    s_mov_b32 exec_lo, 0
    v_add_f32 v64, v66, v67
    s_mov_b32 exec_lo, -1
    v_mov_b32 v65, v64
    s_nop 1
    v_permlane16_swap_b32 v64, v65
    v_add_f32 v64, v64, v65
    s_nop 1
    v_add_f32_dpp v64, v64, v64 row_ror:8 row_mask:0xf bank_mask:0xf
    s_nop 1
    v_add_f32_dpp v64, v64, v64 row_ror:4 row_mask:0xf bank_mask:0xf
    s_nop 1
    v_add_f32_dpp v64, v64, v64 row_ror:2 row_mask:0xf bank_mask:0xf
    s_nop 1
    v_add_f32_dpp v64, v64, v64 row_ror:1 row_mask:0xf bank_mask:0xf
    v_mul_f32 v64, 0x3a800000, v64
    v_mov_b32 v65, v64
    s_nop 1
    v_permlane32_swap_b32 v64, v65
    v_fma_f32 v65, -v64, v64, v65
    v_cvt_pk_bf16_f32 v64, 0, v64
    v_max_f32 v65, 0, v65
    v_fma_f32 v56, -v64, v58, v56
    v_cvt_pk_bf16_f32 v65, 0, v65
    v_add_f32 v65, 0x3727c5ac, v65
    v_cvt_pk_bf16_f32 v65, 0, v65
    v_sqrt_f32 v65, v65
    s_nop 0
    v_cvt_pk_bf16_f32 v65, 0, v65
    v_rcp_f32 v66, v65
    s_nop 0
    v_fma_f32 v56, v56, v66, v59
    v_and_b32 v56, v56, v23
    s_nop 1
    v_or_b32_dpp v60, v56, v60 quad_perm:[0,0,0,0] row_mask:0xf bank_mask:0xf
    v_or_b32_dpp v61, v56, v61 quad_perm:[1,1,1,1] row_mask:0xf bank_mask:0xf
    v_or_b32_dpp v62, v56, v62 quad_perm:[2,2,2,2] row_mask:0xf bank_mask:0xf
    v_or_b32_dpp v63, v56, v63 quad_perm:[3,3,3,3] row_mask:0xf bank_mask:0xf
    s_mov_b32 exec_lo, 0x11111111
    s_mov_b32 exec_hi, 0x11111111
    s_cmp_eq_u32 s15, 0
    s_cbranch_scc1 L_far_108
    buffer_store_dwordx4 v[60:63], v71, s[8:11], s36 offen
L_stj_109:
    s_mov_b64 exec, -1
    s_barrier
    v_add_u32 v19, 32768, v4
    v_xor_b32 v20, 32, v19
    ds_read_b64_tr_b16 v[136:137], v19 offset:0
    ds_read_b64_tr_b16 v[138:139], v19 offset:1024
    ds_read_b64_tr_b16 v[140:141], v19 offset:8192
    ds_read_b64_tr_b16 v[142:143], v19 offset:9216
    ds_read_b64_tr_b16 v[144:145], v19 offset:16384
    ds_read_b64_tr_b16 v[146:147], v19 offset:17408
    ds_read_b64_tr_b16 v[148:149], v19 offset:24576
    ds_read_b64_tr_b16 v[150:151], v19 offset:25600
    ds_read_b64_tr_b16 v[152:153], v20 offset:0
    ds_read_b64_tr_b16 v[154:155], v20 offset:1024
    ds_read_b64_tr_b16 v[156:157], v20 offset:8192
    ds_read_b64_tr_b16 v[158:159], v20 offset:9216
    ds_read_b64_tr_b16 v[160:161], v20 offset:16384
    ds_read_b64_tr_b16 v[162:163], v20 offset:17408
    ds_read_b64_tr_b16 v[164:165], v20 offset:24576
    ds_read_b64_tr_b16 v[166:167], v20 offset:25600
    s_nop 0
L_g_110:
    s_mov_b32 s5, 8192
    buffer_load_dwordx4 v[72:75], v18, s[8:11], s5 offen sc1
    s_mov_b32 s5, 48640
    buffer_load_dwordx4 v[76:79], v18, s[8:11], s5 offen sc1
    s_sub_u32 s4, s4, 1
    s_cbranch_scc1 L_end
    s_waitcnt vmcnt(1)
    v_xor_b32 v72, s76, v72
    v_xor_b32 v73, s77, v73
    v_xor_b32 v74, s78, v74
    v_xor_b32 v75, s79, v75
    v_or3_b32 v16, v72, v73, v74
    v_or_b32 v16, v16, v75
    s_waitcnt vmcnt(0)
    v_xor_b32 v76, s76, v76
    v_xor_b32 v77, s77, v77
    v_xor_b32 v78, s78, v78
    v_xor_b32 v79, s79, v79
    v_or3_b32 v16, v16, v76, v77
    v_or3_b32 v16, v16, v78, v79
    v_and_b32 v16, 0xff, v16
    v_cmp_ne_u32 vcc, 0, v16
    v_pk_add_f32 v[106:107], v[74:75], v[78:79]
    v_pk_add_f32 v[104:105], v[72:73], v[76:77]
    s_cbranch_vccnz L_g_110
    s_nop 0
    v_permlane32_swap_b32 v104, v105
    v_permlane32_swap_b32 v106, v107
    v_add_f32 v104, v104, v105
    v_add_f32 v106, v106, v107
    s_nop 1
    v_permlane16_swap_b32 v104, v106
    v_add_f32 v104, v104, v106
    v_cvt_pk_bf16_f32 v104, 0, v104
    v_mul_f32 v106, v104, v104
    v_mul_f32 v107, 0xc0135761, v104
    v_mul_f32 v106, 0x3d372713, v106
    v_fma_f32 v106, v106, v107, v107
    v_exp_f32 v106, v106
    v_mov_b32_dpp v105, v104 row_ror:8 row_mask:0xf bank_mask:0xf
    v_add_f32 v106, 1.0, v106
    v_rcp_f32 v106, v106
    s_nop 0
    v_mul_f32 v104, v104, v106
    v_cvt_pk_bf16_f32 v104, 0, v104
    v_mul_f32 v104, v104, v105
    s_mov_b32 exec_lo, 0xff00ff
    s_mov_b32 exec_hi, 0xff00ff
    v_cvt_pk_bf16_f32 v104, 0, v104
    ds_write_b16_d16_hi v8, v104
    s_mov_b64 exec, -1
L_x_113:
    ds_read_b32 v16, v0 offset:2560
    ds_read_b128 v[24:27], v6 offset:2560
    ds_read_b128 v[28:31], v6 offset:2624
    ds_read_b128 v[32:35], v6 offset:2688
    ds_read_b128 v[36:39], v6 offset:2752
    s_waitcnt lgkmcnt(4)
    v_cmp_eq_u16 vcc, -1, v16
    v_cmp_le_u32 s[6:7], s38, v16
    s_nop 0
    s_or_b64 s[6:7], s[6:7], vcc
    s_cbranch_scc0 L_xd_114
    s_sub_u32 s4, s4, 1
    s_cbranch_scc1 L_end
    s_branch L_x_113
L_xd_114:
    s_waitcnt lgkmcnt(0)
    s_mul_i32 s5, s28, 128
    s_add_u32 s5, s5, s29
    s_add_u32 s5, s5, 3584
    v_mfma_f32_16x16x32_bf16 v[72:75], v[136:139], v[24:27], 0
    v_mfma_f32_16x16x32_bf16 v[72:75], v[140:143], v[28:31], v[72:75]
    v_mfma_f32_16x16x32_bf16 v[72:75], v[144:147], v[32:35], v[72:75]
    v_mfma_f32_16x16x32_bf16 v[72:75], v[148:151], v[36:39], v[72:75]
    v_mfma_f32_16x16x32_bf16 v[76:79], v[152:155], v[24:27], 0
    v_mfma_f32_16x16x32_bf16 v[76:79], v[156:159], v[28:31], v[76:79]
    v_mfma_f32_16x16x32_bf16 v[76:79], v[160:163], v[32:35], v[76:79]
    v_mfma_f32_16x16x32_bf16 v[76:79], v[164:167], v[36:39], v[76:79]
    s_mov_b32 exec_lo, 0x10001
    s_mov_b32 exec_hi, 0x10001
    s_nop 1
    v_and_or_b32 v80, v72, v23, s76
    v_and_or_b32 v81, v73, v23, s77
    v_and_or_b32 v82, v74, v23, s78
    v_and_or_b32 v83, v75, v23, s79
    s_mov_b32 exec_lo, 0x20002
    s_mov_b32 exec_hi, 0x20002
    v_and_or_b32 v80, v76, v23, s76
    v_and_or_b32 v81, v77, v23, s77
    v_and_or_b32 v82, v78, v23, s78
    v_and_or_b32 v83, v79, v23, s79
    s_mov_b32 exec_lo, 0x30003
    s_mov_b32 exec_hi, 0x30003
    buffer_store_dwordx4 v[80:83], v5, s[8:11], s5 offen sc1
    s_mov_b64 exec, -1
    s_lshr_b32 s5, s31, 3
    s_cmp_lg_u32 s5, 0
    s_cbranch_scc1 L_fin
    v_mov_b32 v116, 0
    v_mov_b32 v117, 0
    v_mov_b32 v118, 0
    v_mov_b32 v119, 0
    s_lshl_b32 s36, s32, 1
    s_waitcnt vmcnt(0)
    s_nop 0
L_g_115:
    s_mov_b32 s5, 3584
    buffer_load_dwordx4 v[104:107], v17, s[8:11], s5 offen sc1
    s_mov_b32 s5, 650752
    buffer_load_dwordx4 v[108:111], v17, s[8:11], s5 offen sc1
    s_mov_b32 s5, 1297920
    buffer_load_dwordx4 v[112:115], v17, s[8:11], s5 offen sc1
    s_mov_b32 exec_lo, 0xffffffff
    s_mov_b32 exec_hi, 0x0
    s_mov_b32 s5, 1945088
    buffer_load_dwordx4 v[116:119], v17, s[8:11], s5 offen sc1
    s_mov_b64 exec, -1
    s_sub_u32 s4, s4, 1
    s_cbranch_scc1 L_end
    s_waitcnt vmcnt(3)
    v_xor_b32 v104, s76, v104
    v_xor_b32 v105, s77, v105
    v_xor_b32 v106, s78, v106
    v_xor_b32 v107, s79, v107
    v_or3_b32 v16, v104, v105, v106
    v_or_b32 v16, v16, v107
    s_waitcnt vmcnt(2)
    v_xor_b32 v108, s76, v108
    v_xor_b32 v109, s77, v109
    v_xor_b32 v110, s78, v110
    v_xor_b32 v111, s79, v111
    v_or3_b32 v16, v16, v108, v109
    v_or3_b32 v16, v16, v110, v111
    v_pk_add_f32 v[122:123], v[106:107], v[110:111]
    v_pk_add_f32 v[120:121], v[104:105], v[108:109]
    s_waitcnt vmcnt(1)
    v_xor_b32 v112, s76, v112
    v_xor_b32 v113, s77, v113
    v_xor_b32 v114, s78, v114
    v_xor_b32 v115, s79, v115
    v_or3_b32 v16, v16, v112, v113
    v_or3_b32 v16, v16, v114, v115
    v_pk_add_f32 v[122:123], v[122:123], v[114:115]
    v_pk_add_f32 v[120:121], v[120:121], v[112:113]
    s_waitcnt vmcnt(0)
    s_mov_b32 exec_lo, 0xffffffff
    s_mov_b32 exec_hi, 0x0
    v_xor_b32 v116, s76, v116
    v_xor_b32 v117, s77, v117
    v_xor_b32 v118, s78, v118
    v_xor_b32 v119, s79, v119
    s_mov_b64 exec, -1
    v_or3_b32 v16, v16, v116, v117
    v_or3_b32 v16, v16, v118, v119
    v_and_b32 v16, 0xff, v16
    v_cmp_ne_u32 vcc, 0, v16
    v_pk_add_f32 v[122:123], v[122:123], v[118:119]
    v_pk_add_f32 v[120:121], v[120:121], v[116:117]
    s_cbranch_vccnz L_g_115
    s_nop 0
    v_permlane32_swap_b32 v120, v121
    v_permlane32_swap_b32 v122, v123
    v_add_f32 v120, v120, v121
    v_add_f32 v122, v122, v123
    s_nop 1
    v_permlane16_swap_b32 v120, v122
    v_add_f32 v120, v120, v122
    s_nop 1
    v_add_f32_dpp v120, v120, v120 row_ror:8 row_mask:0xf bank_mask:0xf
    v_cvt_pk_bf16_f32 v120, 0, v120
    v_mul_f32 v120, v120, v11
    v_cvt_pk_bf16_f32 v120, 0, v120
    v_add_f32 v120, v9, v120
    s_mov_b32 exec_lo, 0xff00ff
    s_mov_b32 exec_hi, 0xff00ff
    v_cvt_pk_bf16_f32 v120, 0, v120
    buffer_store_short_d16_hi v120, v15, s[24:27], s36 offen sc1
    s_mov_b64 exec, -1
L_fin:
    s_endpgm
L_g_48:
    s_sub_u32 s4, s4, 1
    s_cbranch_scc1 L_end
    s_mov_b64 exec, s[40:41]
    s_cbranch_execz L_gs_118
    s_mov_b32 s5, 6356992
    buffer_load_dwordx2 v[72:73], v15, s[8:11], s5 offen sc1
L_gs_118:
    s_waitcnt vmcnt(0)
    s_mov_b64 exec, -1
L_gc_50:
    v_cmp_ne_u32 s[40:41], v73, v14
    s_nop 0
    s_mov_b64 s[6:7], s[40:41]
    s_cmp_lg_u64 s[6:7], 0
    s_cbranch_scc1 L_g_48
    s_nop 1
    s_branch L_gd_49
L_g_53:
    s_sub_u32 s4, s4, 1
    s_cbranch_scc1 L_end
    s_mov_b64 exec, s[40:41]
    s_cbranch_execz L_gs_119
    s_mov_b32 s5, 512
    buffer_load_dwordx4 v[104:107], v7, s[8:11], s5 offen sc1
L_gs_119:
    s_mov_b64 exec, s[42:43]
    s_cbranch_execz L_gs_120
    s_mov_b32 s5, 1294848
    buffer_load_dwordx4 v[108:111], v7, s[8:11], s5 offen sc1
L_gs_120:
    s_mov_b64 exec, s[44:45]
    s_cbranch_execz L_gs_121
    s_mov_b32 s5, 81408
    buffer_load_dwordx4 v[112:115], v7, s[8:11], s5 offen sc1
L_gs_121:
    s_mov_b64 exec, s[46:47]
    s_cbranch_execz L_gs_122
    s_mov_b32 s5, 1375744
    buffer_load_dwordx4 v[116:119], v7, s[8:11], s5 offen sc1
L_gs_122:
    s_waitcnt vmcnt(0)
    s_mov_b64 exec, -1
L_gc_55:
    v_max3_u32 v16, v104, v105, v106
    v_max_u32 v16, v16, v107
    v_cmp_eq_u32 s[40:41], -1, v16
    v_max3_u32 v16, v108, v109, v110
    v_max_u32 v16, v16, v111
    v_cmp_eq_u32 s[42:43], -1, v16
    v_max3_u32 v16, v112, v113, v114
    v_max_u32 v16, v16, v115
    v_cmp_eq_u32 s[44:45], -1, v16
    v_max3_u32 v16, v116, v117, v118
    v_max_u32 v16, v16, v119
    v_cmp_eq_u32 s[46:47], -1, v16
    s_mov_b64 s[6:7], s[40:41]
    s_or_b64 s[6:7], s[6:7], s[42:43]
    s_or_b64 s[6:7], s[6:7], s[44:45]
    s_or_b64 s[6:7], s[6:7], s[46:47]
    s_cmp_lg_u64 s[6:7], 0
    s_cbranch_scc1 L_g_53
    s_nop 1
    s_branch L_gd_54
L_g_60:
    s_sub_u32 s4, s4, 1
    s_cbranch_scc1 L_end
    s_mov_b64 exec, s[40:41]
    s_cbranch_execz L_gs_123
    buffer_load_dwordx4 v[72:75], v7, s[8:11], 0 offen sc1
L_gs_123:
    s_mov_b64 exec, s[42:43]
    s_cbranch_execz L_gs_124
    s_mov_b32 s5, 10112
    buffer_load_dwordx4 v[76:79], v7, s[8:11], s5 offen sc1
L_gs_124:
    s_mov_b64 exec, s[44:45]
    s_cbranch_execz L_gs_125
    s_mov_b32 s5, 20224
    buffer_load_dwordx4 v[80:83], v7, s[8:11], s5 offen sc1
L_gs_125:
    s_mov_b64 exec, s[46:47]
    s_cbranch_execz L_gs_126
    s_mov_b32 s5, 30336
    buffer_load_dwordx4 v[84:87], v7, s[8:11], s5 offen sc1
L_gs_126:
    s_mov_b64 exec, s[48:49]
    s_cbranch_execz L_gs_127
    s_mov_b32 s5, 40448
    buffer_load_dwordx4 v[88:91], v7, s[8:11], s5 offen sc1
L_gs_127:
    s_mov_b64 exec, s[50:51]
    s_cbranch_execz L_gs_128
    s_mov_b32 s5, 50560
    buffer_load_dwordx4 v[92:95], v7, s[8:11], s5 offen sc1
L_gs_128:
    s_mov_b64 exec, s[52:53]
    s_cbranch_execz L_gs_129
    s_mov_b32 s5, 60672
    buffer_load_dwordx4 v[96:99], v7, s[8:11], s5 offen sc1
L_gs_129:
    s_mov_b64 exec, s[54:55]
    s_cbranch_execz L_gs_130
    s_mov_b32 s5, 70784
    buffer_load_dwordx4 v[100:103], v7, s[8:11], s5 offen sc1
L_gs_130:
    s_waitcnt vmcnt(0)
    s_mov_b64 exec, -1
L_gc_62:
    v_max3_u32 v16, v72, v73, v74
    v_max_u32 v16, v16, v75
    v_cmp_eq_u32 s[40:41], -1, v16
    v_max3_u32 v16, v76, v77, v78
    v_max_u32 v16, v16, v79
    v_cmp_eq_u32 s[42:43], -1, v16
    v_max3_u32 v16, v80, v81, v82
    v_max_u32 v16, v16, v83
    v_cmp_eq_u32 s[44:45], -1, v16
    v_max3_u32 v16, v84, v85, v86
    v_max_u32 v16, v16, v87
    v_cmp_eq_u32 s[46:47], -1, v16
    v_max3_u32 v16, v88, v89, v90
    v_max_u32 v16, v16, v91
    v_cmp_eq_u32 s[48:49], -1, v16
    v_max3_u32 v16, v92, v93, v94
    v_max_u32 v16, v16, v95
    v_cmp_eq_u32 s[50:51], -1, v16
    v_max3_u32 v16, v96, v97, v98
    v_max_u32 v16, v16, v99
    v_cmp_eq_u32 s[52:53], -1, v16
    v_max3_u32 v16, v100, v101, v102
    v_max_u32 v16, v16, v103
    v_cmp_eq_u32 s[54:55], -1, v16
    s_mov_b64 s[6:7], s[40:41]
    s_or_b64 s[6:7], s[6:7], s[42:43]
    s_or_b64 s[6:7], s[6:7], s[44:45]
    s_or_b64 s[6:7], s[6:7], s[46:47]
    s_or_b64 s[6:7], s[6:7], s[48:49]
    s_or_b64 s[6:7], s[6:7], s[50:51]
    s_or_b64 s[6:7], s[6:7], s[52:53]
    s_or_b64 s[6:7], s[6:7], s[54:55]
    s_cmp_lg_u64 s[6:7], 0
    s_cbranch_scc1 L_g_60
    s_nop 1
    s_branch L_gd_61
L_g_65:
    s_sub_u32 s4, s4, 1
    s_cbranch_scc1 L_end
    s_mov_b64 exec, s[40:41]
    s_cbranch_execz L_gs_131
    s_mov_b32 s5, 2048
    buffer_load_dwordx4 v[72:75], v7, s[8:11], s5 offen sc1
L_gs_131:
    s_mov_b64 exec, s[42:43]
    s_cbranch_execz L_gs_132
    s_mov_b32 s5, 1296384
    buffer_load_dwordx4 v[76:79], v7, s[8:11], s5 offen sc1
L_gs_132:
    s_mov_b64 exec, s[44:45]
    s_cbranch_execz L_gs_133
    s_mov_b32 s5, 82944
    buffer_load_dwordx4 v[80:83], v7, s[8:11], s5 offen sc1
L_gs_133:
    s_mov_b64 exec, s[46:47]
    s_cbranch_execz L_gs_134
    s_mov_b32 s5, 1377280
    buffer_load_dwordx4 v[84:87], v7, s[8:11], s5 offen sc1
L_gs_134:
    s_mov_b64 exec, s[48:49]
    s_cbranch_execz L_gs_135
    s_mov_b32 s5, 2560
    buffer_load_dwordx4 v[88:91], v7, s[8:11], s5 offen sc1
L_gs_135:
    s_mov_b64 exec, s[50:51]
    s_cbranch_execz L_gs_136
    s_mov_b32 s5, 1296896
    buffer_load_dwordx4 v[92:95], v7, s[8:11], s5 offen sc1
L_gs_136:
    s_mov_b64 exec, s[52:53]
    s_cbranch_execz L_gs_137
    s_mov_b32 s5, 83456
    buffer_load_dwordx4 v[96:99], v7, s[8:11], s5 offen sc1
L_gs_137:
    s_mov_b64 exec, s[54:55]
    s_cbranch_execz L_gs_138
    s_mov_b32 s5, 1377792
    buffer_load_dwordx4 v[100:103], v7, s[8:11], s5 offen sc1
L_gs_138:
    s_waitcnt vmcnt(0)
    s_mov_b64 exec, s[40:41]
    v_xor_b32 v72, s76, v72
    v_xor_b32 v73, s77, v73
    v_xor_b32 v74, s78, v74
    v_xor_b32 v75, s79, v75
    s_mov_b64 exec, s[42:43]
    v_xor_b32 v76, s76, v76
    v_xor_b32 v77, s77, v77
    v_xor_b32 v78, s78, v78
    v_xor_b32 v79, s79, v79
    s_mov_b64 exec, s[44:45]
    v_xor_b32 v80, s76, v80
    v_xor_b32 v81, s77, v81
    v_xor_b32 v82, s78, v82
    v_xor_b32 v83, s79, v83
    s_mov_b64 exec, s[46:47]
    v_xor_b32 v84, s76, v84
    v_xor_b32 v85, s77, v85
    v_xor_b32 v86, s78, v86
    v_xor_b32 v87, s79, v87
    s_mov_b64 exec, s[48:49]
    v_xor_b32 v88, s76, v88
    v_xor_b32 v89, s77, v89
    v_xor_b32 v90, s78, v90
    v_xor_b32 v91, s79, v91
    s_mov_b64 exec, s[50:51]
    v_xor_b32 v92, s76, v92
    v_xor_b32 v93, s77, v93
    v_xor_b32 v94, s78, v94
    v_xor_b32 v95, s79, v95
    s_mov_b64 exec, s[52:53]
    v_xor_b32 v96, s76, v96
    v_xor_b32 v97, s77, v97
    v_xor_b32 v98, s78, v98
    v_xor_b32 v99, s79, v99
    s_mov_b64 exec, s[54:55]
    v_xor_b32 v100, s76, v100
    v_xor_b32 v101, s77, v101
    v_xor_b32 v102, s78, v102
    v_xor_b32 v103, s79, v103
    s_mov_b64 exec, -1
L_gc_67:
    v_or3_b32 v16, v72, v73, v74
    v_or_b32 v16, v16, v75
    v_and_b32 v16, 0xff, v16
    v_cmp_ne_u32 s[40:41], 0, v16
    v_or3_b32 v16, v76, v77, v78
    v_or_b32 v16, v16, v79
    v_and_b32 v16, 0xff, v16
    v_cmp_ne_u32 s[42:43], 0, v16
    v_or3_b32 v16, v80, v81, v82
    v_or_b32 v16, v16, v83
    v_and_b32 v16, 0xff, v16
    v_cmp_ne_u32 s[44:45], 0, v16
    v_or3_b32 v16, v84, v85, v86
    v_or_b32 v16, v16, v87
    v_and_b32 v16, 0xff, v16
    v_cmp_ne_u32 s[46:47], 0, v16
    v_or3_b32 v16, v88, v89, v90
    v_or_b32 v16, v16, v91
    v_and_b32 v16, 0xff, v16
    v_cmp_ne_u32 s[48:49], 0, v16
    v_or3_b32 v16, v92, v93, v94
    v_or_b32 v16, v16, v95
    v_and_b32 v16, 0xff, v16
    v_cmp_ne_u32 s[50:51], 0, v16
    v_or3_b32 v16, v96, v97, v98
    v_or_b32 v16, v16, v99
    v_and_b32 v16, 0xff, v16
    v_cmp_ne_u32 s[52:53], 0, v16
    v_or3_b32 v16, v100, v101, v102
    v_or_b32 v16, v16, v103
    v_and_b32 v16, 0xff, v16
    v_cmp_ne_u32 s[54:55], 0, v16
    s_mov_b64 s[6:7], s[40:41]
    s_or_b64 s[6:7], s[6:7], s[42:43]
    s_or_b64 s[6:7], s[6:7], s[44:45]
    s_or_b64 s[6:7], s[6:7], s[46:47]
    s_or_b64 s[6:7], s[6:7], s[48:49]
    s_or_b64 s[6:7], s[6:7], s[50:51]
    s_or_b64 s[6:7], s[6:7], s[52:53]
    s_or_b64 s[6:7], s[6:7], s[54:55]
    s_cmp_lg_u64 s[6:7], 0
    s_cbranch_scc1 L_g_65
    s_nop 1
    s_branch L_gd_66
L_g_70:
    s_sub_u32 s4, s4, 1
    s_cbranch_scc1 L_end
    s_mov_b64 exec, s[40:41]
    s_cbranch_execz L_gs_139
    buffer_load_dwordx2 v[104:105], v7, s[8:11], 0 offen sc1
L_gs_139:
    s_mov_b64 exec, s[42:43]
    s_cbranch_execz L_gs_140
    s_mov_b32 s5, 512
    buffer_load_dwordx2 v[106:107], v7, s[8:11], s5 offen sc1
L_gs_140:
    s_mov_b64 exec, s[44:45]
    s_cbranch_execz L_gs_141
    s_mov_b32 s5, 1024
    buffer_load_dwordx2 v[108:109], v7, s[8:11], s5 offen sc1
L_gs_141:
    s_mov_b64 exec, s[46:47]
    s_cbranch_execz L_gs_142
    s_mov_b32 s5, 1536
    buffer_load_dwordx2 v[110:111], v7, s[8:11], s5 offen sc1
L_gs_142:
    s_mov_b64 exec, s[48:49]
    s_cbranch_execz L_gs_143
    s_mov_b32 s5, 2048
    buffer_load_dwordx2 v[112:113], v7, s[8:11], s5 offen sc1
L_gs_143:
    s_mov_b64 exec, s[50:51]
    s_cbranch_execz L_gs_144
    s_mov_b32 s5, 2560
    buffer_load_dwordx2 v[114:115], v7, s[8:11], s5 offen sc1
L_gs_144:
    s_mov_b64 exec, s[52:53]
    s_cbranch_execz L_gs_145
    s_mov_b32 s5, 3072
    buffer_load_dwordx2 v[116:117], v7, s[8:11], s5 offen sc1
L_gs_145:
    s_mov_b64 exec, s[54:55]
    s_cbranch_execz L_gs_146
    s_mov_b32 s5, 3584
    buffer_load_dwordx2 v[118:119], v7, s[8:11], s5 offen sc1
L_gs_146:
    s_waitcnt vmcnt(0)
    s_mov_b64 exec, -1
L_gc_72:
    v_max_u32 v16, v104, v105
    v_cmp_eq_u32 s[40:41], -1, v16
    v_max_u32 v16, v106, v107
    v_cmp_eq_u32 s[42:43], -1, v16
    v_max_u32 v16, v108, v109
    v_cmp_eq_u32 s[44:45], -1, v16
    v_max_u32 v16, v110, v111
    v_cmp_eq_u32 s[46:47], -1, v16
    v_max_u32 v16, v112, v113
    v_cmp_eq_u32 s[48:49], -1, v16
    v_max_u32 v16, v114, v115
    v_cmp_eq_u32 s[50:51], -1, v16
    v_max_u32 v16, v116, v117
    v_cmp_eq_u32 s[52:53], -1, v16
    v_max_u32 v16, v118, v119
    v_cmp_eq_u32 s[54:55], -1, v16
    s_mov_b64 s[6:7], s[40:41]
    s_or_b64 s[6:7], s[6:7], s[42:43]
    s_or_b64 s[6:7], s[6:7], s[44:45]
    s_or_b64 s[6:7], s[6:7], s[46:47]
    s_or_b64 s[6:7], s[6:7], s[48:49]
    s_or_b64 s[6:7], s[6:7], s[50:51]
    s_or_b64 s[6:7], s[6:7], s[52:53]
    s_or_b64 s[6:7], s[6:7], s[54:55]
    s_cmp_lg_u64 s[6:7], 0
    s_cbranch_scc1 L_g_70
    s_nop 1
    s_branch L_gd_71
L_g_79:
    s_sub_u32 s4, s4, 1
    s_cbranch_scc1 L_end
    s_mov_b64 exec, s[40:41]
    s_cbranch_execz L_gs_147
    s_mov_b32 s5, 6291456
    buffer_load_dwordx4 v[72:75], v7, s[8:11], s5 offen sc1
L_gs_147:
    s_waitcnt vmcnt(0)
    s_mov_b64 exec, s[40:41]
    v_xor_b32 v72, s76, v72
    v_xor_b32 v73, s77, v73
    v_xor_b32 v74, s78, v74
    v_xor_b32 v75, s79, v75
    s_mov_b64 exec, -1
L_gc_81:
    v_or3_b32 v16, v72, v73, v74
    v_or_b32 v16, v16, v75
    v_and_b32 v16, 0xff, v16
    v_cmp_ne_u32 s[40:41], 0, v16
    s_nop 0
    s_mov_b64 s[6:7], s[40:41]
    s_cmp_lg_u64 s[6:7], 0
    s_cbranch_scc1 L_g_79
    s_nop 1
    s_branch L_gd_80
L_g_88:
    s_sub_u32 s4, s4, 1
    s_cbranch_scc1 L_end
    s_mov_b64 exec, s[40:41]
    s_cbranch_execz L_gs_148
    s_mov_b32 s5, 4096
    buffer_load_dwordx4 v[104:107], v21, s[8:11], s5 offen sc1
L_gs_148:
    s_mov_b64 exec, s[42:43]
    s_cbranch_execz L_gs_149
    s_mov_b32 s5, 327680
    buffer_load_dwordx4 v[108:111], v21, s[8:11], s5 offen sc1
L_gs_149:
    s_mov_b64 exec, s[44:45]
    s_cbranch_execz L_gs_150
    s_mov_b32 s5, 651264
    buffer_load_dwordx4 v[112:115], v21, s[8:11], s5 offen sc1
L_gs_150:
    s_mov_b64 exec, s[46:47]
    s_cbranch_execz L_gs_151
    s_mov_b32 s5, 974848
    buffer_load_dwordx4 v[116:119], v21, s[8:11], s5 offen sc1
L_gs_151:
    s_mov_b64 exec, s[48:49]
    s_cbranch_execz L_gs_152
    s_mov_b32 s5, 1298432
    buffer_load_dwordx4 v[120:123], v21, s[8:11], s5 offen sc1
L_gs_152:
    s_mov_b64 exec, s[50:51]
    s_cbranch_execz L_gs_153
    s_mov_b32 s5, 1622016
    buffer_load_dwordx4 v[124:127], v21, s[8:11], s5 offen sc1
L_gs_153:
    s_mov_b64 exec, s[52:53]
    s_cbranch_execz L_gs_154
    s_mov_b32 s5, 1945600
    buffer_load_dwordx4 v[128:131], v21, s[8:11], s5 offen sc1
L_gs_154:
    s_mov_b64 exec, s[54:55]
    s_cbranch_execz L_gs_155
    s_mov_b32 s5, 2269184
    buffer_load_dwordx4 v[132:135], v21, s[8:11], s5 offen sc1
L_gs_155:
    s_waitcnt vmcnt(0)
    s_mov_b64 exec, s[40:41]
    v_xor_b32 v104, s76, v104
    v_xor_b32 v105, s77, v105
    v_xor_b32 v106, s78, v106
    v_xor_b32 v107, s79, v107
    s_mov_b64 exec, s[42:43]
    v_xor_b32 v108, s76, v108
    v_xor_b32 v109, s77, v109
    v_xor_b32 v110, s78, v110
    v_xor_b32 v111, s79, v111
    s_mov_b64 exec, s[44:45]
    v_xor_b32 v112, s76, v112
    v_xor_b32 v113, s77, v113
    v_xor_b32 v114, s78, v114
    v_xor_b32 v115, s79, v115
    s_mov_b64 exec, s[46:47]
    v_xor_b32 v116, s76, v116
    v_xor_b32 v117, s77, v117
    v_xor_b32 v118, s78, v118
    v_xor_b32 v119, s79, v119
    s_mov_b64 exec, s[48:49]
    v_xor_b32 v120, s76, v120
    v_xor_b32 v121, s77, v121
    v_xor_b32 v122, s78, v122
    v_xor_b32 v123, s79, v123
    s_mov_b64 exec, s[50:51]
    v_xor_b32 v124, s76, v124
    v_xor_b32 v125, s77, v125
    v_xor_b32 v126, s78, v126
    v_xor_b32 v127, s79, v127
    s_mov_b64 exec, s[52:53]
    v_xor_b32 v128, s76, v128
    v_xor_b32 v129, s77, v129
    v_xor_b32 v130, s78, v130
    v_xor_b32 v131, s79, v131
    s_mov_b64 exec, s[54:55]
    v_xor_b32 v132, s76, v132
    v_xor_b32 v133, s77, v133
    v_xor_b32 v134, s78, v134
    v_xor_b32 v135, s79, v135
    s_mov_b64 exec, -1
L_gc_90:
    v_or3_b32 v16, v104, v105, v106
    v_or_b32 v16, v16, v107
    v_and_b32 v16, 0xff, v16
    v_cmp_ne_u32 s[40:41], 0, v16
    v_or3_b32 v16, v108, v109, v110
    v_or_b32 v16, v16, v111
    v_and_b32 v16, 0xff, v16
    v_cmp_ne_u32 s[42:43], 0, v16
    v_or3_b32 v16, v112, v113, v114
    v_or_b32 v16, v16, v115
    v_and_b32 v16, 0xff, v16
    v_cmp_ne_u32 s[44:45], 0, v16
    v_or3_b32 v16, v116, v117, v118
    v_or_b32 v16, v16, v119
    v_and_b32 v16, 0xff, v16
    v_cmp_ne_u32 s[46:47], 0, v16
    v_or3_b32 v16, v120, v121, v122
    v_or_b32 v16, v16, v123
    v_and_b32 v16, 0xff, v16
    v_cmp_ne_u32 s[48:49], 0, v16
    v_or3_b32 v16, v124, v125, v126
    v_or_b32 v16, v16, v127
    v_and_b32 v16, 0xff, v16
    v_cmp_ne_u32 s[50:51], 0, v16
    v_or3_b32 v16, v128, v129, v130
    v_or_b32 v16, v16, v131
    v_and_b32 v16, 0xff, v16
    v_cmp_ne_u32 s[52:53], 0, v16
    v_or3_b32 v16, v132, v133, v134
    v_or_b32 v16, v16, v135
    v_and_b32 v16, 0xff, v16
    v_cmp_ne_u32 s[54:55], 0, v16
    s_mov_b64 s[6:7], s[40:41]
    s_or_b64 s[6:7], s[6:7], s[42:43]
    s_or_b64 s[6:7], s[6:7], s[44:45]
    s_or_b64 s[6:7], s[6:7], s[46:47]
    s_or_b64 s[6:7], s[6:7], s[48:49]
    s_or_b64 s[6:7], s[6:7], s[50:51]
    s_or_b64 s[6:7], s[6:7], s[52:53]
    s_or_b64 s[6:7], s[6:7], s[54:55]
    s_cmp_lg_u64 s[6:7], 0
    s_cbranch_scc1 L_g_88
    v_pk_add_f32 v[142:143], v[106:107], v[110:111]
    v_pk_add_f32 v[140:141], v[104:105], v[108:109]
    v_pk_add_f32 v[142:143], v[142:143], v[114:115]
    v_pk_add_f32 v[140:141], v[140:141], v[112:113]
    v_pk_add_f32 v[142:143], v[142:143], v[118:119]
    v_pk_add_f32 v[140:141], v[140:141], v[116:117]
    v_pk_add_f32 v[142:143], v[142:143], v[122:123]
    v_pk_add_f32 v[140:141], v[140:141], v[120:121]
    v_pk_add_f32 v[142:143], v[142:143], v[126:127]
    v_pk_add_f32 v[140:141], v[140:141], v[124:125]
    v_pk_add_f32 v[142:143], v[142:143], v[130:131]
    v_pk_add_f32 v[140:141], v[140:141], v[128:129]
    v_pk_add_f32 v[142:143], v[142:143], v[134:135]
    v_pk_add_f32 v[140:141], v[140:141], v[132:133]
    s_nop 1
    s_branch L_gd_89
L_g_101:
    s_sub_u32 s4, s4, 1
    s_cbranch_scc1 L_end
    s_mov_b64 exec, s[40:41]
    s_cbranch_execz L_gs_156
    s_mov_b32 s5, 3072
    buffer_load_dwordx4 v[40:43], v7, s[8:11], s5 offen sc1
L_gs_156:
    s_mov_b64 exec, s[42:43]
    s_cbranch_execz L_gs_157
    s_mov_b32 s5, 650240
    buffer_load_dwordx4 v[44:47], v7, s[8:11], s5 offen sc1
L_gs_157:
    s_mov_b64 exec, s[44:45]
    s_cbranch_execz L_gs_158
    s_mov_b32 s5, 1297408
    buffer_load_dwordx4 v[48:51], v7, s[8:11], s5 offen sc1
L_gs_158:
    s_mov_b64 exec, s[46:47]
    s_cbranch_execz L_gs_159
    s_mov_b32 s5, 1944576
    buffer_load_dwordx4 v[52:55], v7, s[8:11], s5 offen sc1
L_gs_159:
    s_waitcnt vmcnt(0)
    s_mov_b64 exec, s[40:41]
    v_xor_b32 v40, s76, v40
    v_xor_b32 v41, s77, v41
    v_xor_b32 v42, s78, v42
    v_xor_b32 v43, s79, v43
    s_mov_b64 exec, s[42:43]
    v_xor_b32 v44, s76, v44
    v_xor_b32 v45, s77, v45
    v_xor_b32 v46, s78, v46
    v_xor_b32 v47, s79, v47
    s_mov_b64 exec, s[44:45]
    v_xor_b32 v48, s76, v48
    v_xor_b32 v49, s77, v49
    v_xor_b32 v50, s78, v50
    v_xor_b32 v51, s79, v51
    s_mov_b64 exec, s[46:47]
    v_xor_b32 v52, s76, v52
    v_xor_b32 v53, s77, v53
    v_xor_b32 v54, s78, v54
    v_xor_b32 v55, s79, v55
    s_mov_b64 exec, -1
L_gc_103:
    v_or3_b32 v16, v40, v41, v42
    v_or_b32 v16, v16, v43
    v_and_b32 v16, 0xff, v16
    v_cmp_ne_u32 s[40:41], 0, v16
    v_or3_b32 v16, v44, v45, v46
    v_or_b32 v16, v16, v47
    v_and_b32 v16, 0xff, v16
    v_cmp_ne_u32 s[42:43], 0, v16
    v_or3_b32 v16, v48, v49, v50
    v_or_b32 v16, v16, v51
    v_and_b32 v16, 0xff, v16
    v_cmp_ne_u32 s[44:45], 0, v16
    v_or3_b32 v16, v52, v53, v54
    v_or_b32 v16, v16, v55
    v_and_b32 v16, 0xff, v16
    v_cmp_ne_u32 s[46:47], 0, v16
    s_mov_b64 s[6:7], s[40:41]
    s_or_b64 s[6:7], s[6:7], s[42:43]
    s_or_b64 s[6:7], s[6:7], s[44:45]
    s_or_b64 s[6:7], s[6:7], s[46:47]
    s_cmp_lg_u64 s[6:7], 0
    s_cbranch_scc1 L_g_101
    v_pk_add_f32 v[66:67], v[42:43], v[46:47]
    v_pk_add_f32 v[64:65], v[40:41], v[44:45]
    v_pk_add_f32 v[66:67], v[66:67], v[50:51]
    v_pk_add_f32 v[64:65], v[64:65], v[48:49]
    v_pk_add_f32 v[66:67], v[66:67], v[54:55]
    v_pk_add_f32 v[64:65], v[64:65], v[52:53]
    s_nop 1
    s_branch L_gd_102
L_far_104:
    buffer_store_dwordx4 v[40:43], off, s[8:11], s37 sc1
    s_branch L_stj_105
L_far_108:
    buffer_store_dwordx4 v[60:63], v71, s[8:11], s36 offen sc1
    s_branch L_stj_109
L_end:
    s_endpgm
.section .rodata,"a"
.p2align 6
.amdhsa_kernel adaLN_cond__gqa_block_cached__glu_gated_geglu__decode_kernel
  .amdhsa_next_free_vgpr 168
  .amdhsa_next_free_sgpr 102
  .amdhsa_accum_offset 168
  .amdhsa_group_segment_fixed_size 0
  .amdhsa_kernarg_size 112
  .amdhsa_user_sgpr_count 2
  .amdhsa_user_sgpr_kernarg_segment_ptr 1
  .amdhsa_system_sgpr_workgroup_id_x 1
  .amdhsa_float_denorm_mode_32 3
.end_amdhsa_kernel
```
